```python
import torch

def _softmax(x, axis=-1):
    return torch.softmax(x, dim=axis)
def _gelu(x):
    return torch.nn.functional.gelu(x, approximate="tanh")
def _silu(x):
    return torch.nn.functional.silu(x)
def _sigmoid(x):
    return torch.sigmoid(x)
def _layernorm(x, axis=-1, eps=1e-5):
    m = x.mean(dim=axis, keepdim=True)
    v = x.var(dim=axis, keepdim=True, unbiased=False)
    return (x - m) / torch.sqrt(v + eps)
def _scatter_add(tgt, idx, src, axis=0):
    return tgt.clone().index_add_(axis, idx, src)
def _segment_sum(src, seg, n):
    out = torch.zeros((n,) + src.shape[1:], dtype=src.dtype)
    return out.index_add_(0, seg, src)
def _pad(x, pw):
    flat = tuple(v for pair in reversed(pw) for v in pair)
    return torch.nn.functional.pad(x, flat)

kernel_name = 'standalone__softmax_full_causal__prompt'

def setup_inputs():

    _w = (lambda a: (lambda t: t.to(torch.bfloat16) if t.is_floating_point() else t)(torch.as_tensor(a)))
    B, H, S, D = 1, 16, 2048, 256
    return {
        "q": _w((lambda *s: torch.randn(*s, dtype=torch.bfloat16) * 0.8)(B, H, S, D)),
        "k": _w((lambda *s: torch.randn(*s, dtype=torch.bfloat16) * 0.8)(B, H, S, D)),
        "v": _w((lambda *s: torch.randn(*s, dtype=torch.bfloat16) * 0.05)(B, H, S, D)),
    }

def reference(q, k, v):
    B, H, S, D = q.shape[0], q.shape[1], q.shape[2], q.shape[3]
    scale = D ** -0.5
    scores = torch.einsum('bhqd,bhkd->bhqk', q, k) * scale
    qi = torch.reshape(torch.arange(S), (1, 1, S, 1))
    kj = torch.reshape(torch.arange(S), (1, 1, 1, S))
    causal_bias = (lambda x, dt: x.to(dt))(kj > qi, scores.dtype) * (-1e9)
    attn = _softmax(scores + causal_bias, axis=-1)
    return torch.einsum('bhqk,bhkd->bhqd', attn, v)
```

```asm
; @launch grid=(256,1,1) block=(256,1,1) lds=163840
.amdgcn_target "amdgcn-amd-amdhsa--gfx950"
.text
.globl standalone__softmax_full_causal__prompt_kernel
.p2align 8
.type standalone__softmax_full_causal__prompt_kernel,@function
standalone__softmax_full_causal__prompt_kernel:
    s_cmp_ge_u32 s2, 256
    s_cbranch_scc1 .Lend
    s_load_dwordx4 s[4:7], s[0:1], 0
    s_load_dwordx4 s[8:11], s[0:1], 16
    s_load_dwordx4 s[12:15], s[0:1], 32
    v_lshrrev_b32 v211, 6, v0
    v_and_b32 v210, 63, v0
    s_nop 0
    v_readfirstlane_b32 s60, v211
    s_and_b32 s64, s2, 7
    s_lshr_b32 s65, s2, 3
    s_and_b32 s66, s65, 1
    s_lshl_b32 s64, s64, 1
    s_add_u32 s64, s64, s66
    s_lshr_b32 s65, s65, 1
    s_and_b32 s67, s65, 1
    s_lshl_b32 s85, s65, 16
    s_mov_b32 s97, s85
    s_lshr_b32 s65, s65, 1
    s_lshl_b32 s59, s64, 3
    s_add_u32 s59, s59, s65
    s_lshl_b32 s68, s64, 20
    s_waitcnt lgkmcnt(0)
    s_mov_b32 s70, s6
    s_mov_b32 s71, s7
    s_mov_b32 s72, s8
    s_mov_b32 s73, s9
    s_mov_b32 s74, s10
    s_mov_b32 s75, s11
    s_mov_b32 s76, s12
    s_mov_b32 s77, s13
    s_mov_b32 s78, s14
    s_mov_b32 s79, s15
    s_add_u32 s4, s4, s68
    s_addc_u32 s5, s5, 0
    s_and_b32 s5, s5, 0xffff
    s_mov_b32 s6, 0x100000
    s_mov_b32 s7, 0x00020000
    s_add_u32 s8, s70, s68
    s_addc_u32 s9, s71, 0
    s_and_b32 s9, s9, 0xffff
    s_mov_b32 s10, 0x100000
    s_mov_b32 s11, 0x00020000
    s_add_u32 s12, s72, s68
    s_addc_u32 s13, s73, 0
    s_and_b32 s13, s13, 0xffff
    s_mov_b32 s14, 0x100000
    s_mov_b32 s15, 0x00020000
    s_add_u32 s16, s74, s68
    s_addc_u32 s17, s75, 0
    s_and_b32 s17, s17, 0xffff
    s_mov_b32 s18, 0x100000
    s_mov_b32 s19, 0x00020000
    s_mov_b32 s20, s78
    s_and_b32 s21, s79, 0xffff
    s_mov_b32 s22, 0x10000000
    s_mov_b32 s23, 0x00020000
    s_mov_b32 s24, s76
    s_and_b32 s25, s77, 0xffff
    s_mov_b32 s26, 256
    s_mov_b32 s27, 0x00020000
    s_mov_b32 s28, 0x3db8aa3b
    s_lshl_b32 s29, s60, 13
    s_mov_b32 s35, 0x40000000
    s_lshl_b32 s69, s65, 1
    s_sub_u32 s80, 32, s69
    s_add_u32 s81, s69, 2
    s_sub_u32 s82, 15, s65
    s_lshl_b32 s82, s82, 16
    s_lshl_b32 s83, s65, 16
    s_cmp_lt_u32 s65, 2
    s_cselect_b32 s84, 20, 18
    s_min_u32 s84, s80, s84
    s_sub_u32 s85, s80, s84
    s_cmp_eq_u32 s67, 0
    s_cbranch_scc0 .Lwg1
    s_mov_b32 s50, s82
    s_mov_b32 s51, 0
    s_mov_b32 s52, s84
    s_mov_b32 s38, 1
    s_cmp_lg_u32 s85, 0
    s_cselect_b32 s39, 1, 0
    s_mov_b32 s32, 1
    s_mov_b32 s33, 1
    s_lshl_b32 s34, s84, 15
    s_branch .Lsegdone
.Lwg1:
    s_cmp_lg_u32 s85, 0
    s_cselect_b32 s38, 2, 1
    s_cbranch_scc0 .Lwg1_single
    s_mov_b32 s50, s82
    s_mov_b32 s51, s84
    s_mov_b32 s52, s85
    s_mov_b32 s39, 2
    s_mov_b32 s53, s83
    s_mov_b32 s54, 0
    s_mov_b32 s55, s81
    s_mov_b32 s56, 0
    s_lshl_b32 s32, s80, 15
    s_mov_b32 s33, 0
    s_lshl_b32 s34, s81, 15
    s_branch .Lsegdone
.Lwg1_single:
    s_mov_b32 s50, s83
    s_mov_b32 s51, 0
    s_mov_b32 s52, s81
    s_mov_b32 s39, 0
    s_mov_b32 s32, 1
    s_mov_b32 s33, 1
    s_lshl_b32 s34, s81, 15
.Lsegdone:
    v_and_b32 v211, 31, v210
    v_lshrrev_b32 v212, 5, v210
    s_lshl_b32 s57, s60, 5
    v_add_u32 v213, s57, v211
    v_lshlrev_b32 v214, 9, v213
    v_lshl_add_u32 v214, v212, 4, v214
    v_and_b32 v217, 15, v210
    v_add_u32 v160, 0, v212
    v_xor_b32 v160, v160, v217
    v_lshlrev_b32 v160, 4, v160
    v_lshl_add_u32 v160, v211, 9, v160
    v_add_u32 v161, 2, v212
    v_xor_b32 v161, v161, v217
    v_lshlrev_b32 v161, 4, v161
    v_lshl_add_u32 v161, v211, 9, v161
    v_add_u32 v162, 4, v212
    v_xor_b32 v162, v162, v217
    v_lshlrev_b32 v162, 4, v162
    v_lshl_add_u32 v162, v211, 9, v162
    v_add_u32 v163, 6, v212
    v_xor_b32 v163, v163, v217
    v_lshlrev_b32 v163, 4, v163
    v_lshl_add_u32 v163, v211, 9, v163
    v_add_u32 v164, 8, v212
    v_xor_b32 v164, v164, v217
    v_lshlrev_b32 v164, 4, v164
    v_lshl_add_u32 v164, v211, 9, v164
    v_add_u32 v165, 10, v212
    v_xor_b32 v165, v165, v217
    v_lshlrev_b32 v165, 4, v165
    v_lshl_add_u32 v165, v211, 9, v165
    v_add_u32 v166, 12, v212
    v_xor_b32 v166, v166, v217
    v_lshlrev_b32 v166, 4, v166
    v_lshl_add_u32 v166, v211, 9, v166
    v_add_u32 v167, 14, v212
    v_xor_b32 v167, v167, v217
    v_lshlrev_b32 v167, 4, v167
    v_lshl_add_u32 v167, v211, 9, v167
    v_bfe_u32 v184, v210, 2, 2
    v_and_b32 v185, 3, v210
    v_bfe_u32 v186, v210, 4, 1
    v_lshl_add_u32 v187, v212, 2, v184
    v_lshlrev_b32 v187, 9, v187
    v_lshl_add_u32 v187, v186, 5, v187
    v_lshl_add_u32 v187, v185, 3, v187
    v_add_u32 v187, 0x10000, v187
    v_xor_b32 v168, 0, v184
    v_lshl_add_u32 v168, v168, 6, v187
    v_xor_b32 v169, 1, v184
    v_lshl_add_u32 v169, v169, 6, v187
    v_xor_b32 v170, 2, v184
    v_lshl_add_u32 v170, v170, 6, v187
    v_xor_b32 v171, 3, v184
    v_lshl_add_u32 v171, v171, 6, v187
    v_lshl_add_u32 v188, v212, 9, s29
    v_add_u32 v172, 0, v212
    v_xor_b32 v172, v172, v211
    v_lshl_add_u32 v172, v172, 4, v188
    v_add_u32 v173, 2, v212
    v_xor_b32 v173, v173, v211
    v_lshl_add_u32 v173, v173, 4, v188
    v_add_u32 v174, 4, v212
    v_xor_b32 v174, v174, v211
    v_lshl_add_u32 v174, v174, 4, v188
    v_add_u32 v175, 6, v212
    v_xor_b32 v175, v175, v211
    v_lshl_add_u32 v175, v175, 4, v188
    v_add_u32 v176, 8, v212
    v_xor_b32 v176, v176, v211
    v_lshl_add_u32 v176, v176, 4, v188
    v_add_u32 v176, 0x1000, v176
    v_add_u32 v177, 10, v212
    v_xor_b32 v177, v177, v211
    v_lshl_add_u32 v177, v177, 4, v188
    v_add_u32 v177, 0x1000, v177
    v_add_u32 v178, 12, v212
    v_xor_b32 v178, v178, v211
    v_lshl_add_u32 v178, v178, 4, v188
    v_add_u32 v178, 0x1000, v178
    v_add_u32 v179, 14, v212
    v_xor_b32 v179, v179, v211
    v_lshl_add_u32 v179, v179, 4, v188
    v_add_u32 v179, 0x1000, v179
    v_add_u32 v180, 0, v212
    v_lshlrev_b32 v180, 2, v180
    v_xor_b32 v180, v180, v211
    v_lshl_add_u32 v180, v180, 4, v188
    v_add_u32 v181, 2, v212
    v_lshlrev_b32 v181, 2, v181
    v_xor_b32 v181, v181, v211
    v_lshl_add_u32 v181, v181, 4, v188
    v_add_u32 v182, 0, v212
    v_lshlrev_b32 v182, 2, v182
    v_xor_b32 v182, v182, v211
    v_lshl_add_u32 v182, v182, 4, v188
    v_add_u32 v182, 0x1000, v182
    v_add_u32 v183, 2, v212
    v_lshlrev_b32 v183, 2, v183
    v_xor_b32 v183, v183, v211
    v_lshl_add_u32 v183, v183, 4, v188
    v_add_u32 v183, 0x1000, v183
    v_mov_b32 v209, 0xf149f2ca
    v_mov_b32 v218, 0x47800000
    s_mul_i32 s57, s60, 0x9000
    s_lshl_b32 s58, s59, 18
    s_add_u32 s57, s57, s58
    v_lshl_add_u32 v215, v210, 4, s57
    v_and_b32 v219, 7, v210
    s_lshl_b32 s57, s65, 12
    s_lshl_b32 s58, s60, 10
    s_add_u32 s57, s57, s58
    v_lshl_add_u32 v219, v219, 7, s57
    s_lshl_b32 s30, s51, 15
    s_mov_b32 s31, s30
    s_mov_b32 s68, 1
    s_mov_b32 s69, 0
    s_mov_b32 s70, 0
    s_lshl_b32 s57, s60, 14
    s_cmp_lt_u32 s60, 2
    s_cselect_b32 s58, 2, 1
    s_lshl_b32 s58, s58, 16
    s_add_u32 s71, s57, s58
    s_add_u32 s57, s50, s29
    s_add_u32 m0, s71, 0
    s_nop 0
    buffer_load_dwordx4 v172, s[4:7], s57 offen offset:0 lds
    buffer_load_dwordx4 v173, s[4:7], s57 offen offset:1024 lds
    buffer_load_dwordx4 v174, s[4:7], s57 offen offset:2048 lds
    buffer_load_dwordx4 v175, s[4:7], s57 offen offset:3072 lds
    s_add_u32 m0, s71, 4096
    s_nop 0
    buffer_load_dwordx4 v176, s[4:7], s57 offen offset:0 lds
    buffer_load_dwordx4 v177, s[4:7], s57 offen offset:1024 lds
    buffer_load_dwordx4 v178, s[4:7], s57 offen offset:2048 lds
    buffer_load_dwordx4 v179, s[4:7], s57 offen offset:3072 lds
    s_add_u32 s57, s57, 0x2000
    s_add_u32 m0, s71, 8192
    s_nop 0
    buffer_load_dwordx4 v172, s[4:7], s57 offen offset:0 lds
    buffer_load_dwordx4 v173, s[4:7], s57 offen offset:1024 lds
    buffer_load_dwordx4 v174, s[4:7], s57 offen offset:2048 lds
    buffer_load_dwordx4 v175, s[4:7], s57 offen offset:3072 lds
    s_add_u32 m0, s71, 12288
    s_nop 0
    buffer_load_dwordx4 v176, s[4:7], s57 offen offset:0 lds
    buffer_load_dwordx4 v177, s[4:7], s57 offen offset:1024 lds
    buffer_load_dwordx4 v178, s[4:7], s57 offen offset:2048 lds
    buffer_load_dwordx4 v179, s[4:7], s57 offen offset:3072 lds
    s_add_u32 m0, s29, 0
    s_nop 0
    buffer_load_dwordx4 v172, s[8:11], s30 offen offset:0 lds
    buffer_load_dwordx4 v173, s[8:11], s30 offen offset:1024 lds
    buffer_load_dwordx4 v174, s[8:11], s30 offen offset:2048 lds
    buffer_load_dwordx4 v175, s[8:11], s30 offen offset:3072 lds
    s_add_u32 m0, s29, 4096
    s_nop 0
    buffer_load_dwordx4 v176, s[8:11], s30 offen offset:0 lds
    buffer_load_dwordx4 v177, s[8:11], s30 offen offset:1024 lds
    buffer_load_dwordx4 v178, s[8:11], s30 offen offset:2048 lds
    buffer_load_dwordx4 v179, s[8:11], s30 offen offset:3072 lds
    s_mov_b32 s31, s30
    s_add_u32 s30, s30, 0x8000
    s_cmp_eq_u32 s30, s32
    s_cselect_b32 s30, s33, s30
    s_cmp_eq_u32 s30, s34
    s_cselect_b32 s30, s35, s30
    s_add_u32 m0, s29, 65536
    s_nop 0
    buffer_load_dwordx4 v180, s[12:15], s31 offen offset:0 lds
    buffer_load_dwordx4 v181, s[12:15], s31 offen offset:1024 lds
    buffer_load_dwordx4 v180, s[12:15], s31 offen offset:2048 lds
    buffer_load_dwordx4 v181, s[12:15], s31 offen offset:3072 lds
    s_add_u32 m0, s29, 69632
    s_nop 0
    buffer_load_dwordx4 v182, s[12:15], s31 offen offset:0 lds
    buffer_load_dwordx4 v183, s[12:15], s31 offen offset:1024 lds
    buffer_load_dwordx4 v182, s[12:15], s31 offen offset:2048 lds
    buffer_load_dwordx4 v183, s[12:15], s31 offen offset:3072 lds
    s_add_u32 m0, s29, 32768
    s_nop 0
    buffer_load_dwordx4 v172, s[8:11], s30 offen offset:0 lds
    buffer_load_dwordx4 v173, s[8:11], s30 offen offset:1024 lds
    buffer_load_dwordx4 v174, s[8:11], s30 offen offset:2048 lds
    buffer_load_dwordx4 v175, s[8:11], s30 offen offset:3072 lds
    s_add_u32 m0, s29, 36864
    s_nop 0
    buffer_load_dwordx4 v176, s[8:11], s30 offen offset:0 lds
    buffer_load_dwordx4 v177, s[8:11], s30 offen offset:1024 lds
    buffer_load_dwordx4 v178, s[8:11], s30 offen offset:2048 lds
    buffer_load_dwordx4 v179, s[8:11], s30 offen offset:3072 lds
    s_mov_b32 s31, s30
    s_add_u32 s30, s30, 0x8000
    s_cmp_eq_u32 s30, s32
    s_cselect_b32 s30, s33, s30
    s_cmp_eq_u32 s30, s34
    s_cselect_b32 s30, s35, s30
    s_mul_i32 s66, s67, 589824
    s_add_u32 s66, s66, 0x8000
    buffer_load_dword v220, v219, s[12:15], s66 offen
    buffer_load_dword v221, v219, s[8:11], s66 offen
    s_add_u32 s66, s66, 0x8000
    buffer_load_dword v220, v219, s[12:15], s66 offen
    buffer_load_dword v221, v219, s[8:11], s66 offen
    s_add_u32 s66, s66, 0x8000
    buffer_load_dword v220, v219, s[12:15], s66 offen
    buffer_load_dword v221, v219, s[8:11], s66 offen
    s_add_u32 s66, s66, 0x8000
    s_waitcnt vmcnt(22)
    s_barrier
    v_add_u32 v184, s71, v160
    v_add_u32 v185, s71, v161
    v_add_u32 v186, s71, v162
    v_add_u32 v187, s71, v163
    v_add_u32 v188, s71, v164
    v_add_u32 v189, s71, v165
    v_add_u32 v190, s71, v166
    v_add_u32 v191, s71, v167
    ds_read_b128 a[128:131], v184 offset:0
    ds_read_b128 a[132:135], v185 offset:0
    ds_read_b128 a[136:139], v186 offset:0
    ds_read_b128 a[140:143], v187 offset:0
    ds_read_b128 a[144:147], v188 offset:0
    ds_read_b128 a[148:151], v189 offset:0
    ds_read_b128 a[152:155], v190 offset:0
    ds_read_b128 a[156:159], v191 offset:0
    s_waitcnt lgkmcnt(0)
    ds_read_b128 a[160:163], v184 offset:256
    ds_read_b128 a[164:167], v185 offset:256
    ds_read_b128 a[168:171], v186 offset:256
    ds_read_b128 a[172:175], v187 offset:256
    ds_read_b128 a[176:179], v188 offset:256
    ds_read_b128 a[180:183], v189 offset:256
    ds_read_b128 a[184:187], v190 offset:256
    ds_read_b128 a[188:191], v191 offset:256
    s_waitcnt lgkmcnt(0)
.Lseg:
    s_lshr_b32 s57, s50, 9
    v_lshrrev_b32 v211, 9, v214
    v_add_u32 v207, s57, v211
    v_lshrrev_b32 v212, 5, v210
    v_lshlrev_b32 v212, 2, v212
    v_sub_u32 v207, v207, v212
    v_accvgpr_write_b32 a0, 0
    v_accvgpr_write_b32 a1, 0
    v_accvgpr_write_b32 a2, 0
    v_accvgpr_write_b32 a3, 0
    v_accvgpr_write_b32 a4, 0
    v_accvgpr_write_b32 a5, 0
    v_accvgpr_write_b32 a6, 0
    v_accvgpr_write_b32 a7, 0
    v_accvgpr_write_b32 a8, 0
    v_accvgpr_write_b32 a9, 0
    v_accvgpr_write_b32 a10, 0
    v_accvgpr_write_b32 a11, 0
    v_accvgpr_write_b32 a12, 0
    v_accvgpr_write_b32 a13, 0
    v_accvgpr_write_b32 a14, 0
    v_accvgpr_write_b32 a15, 0
    v_accvgpr_write_b32 a16, 0
    v_accvgpr_write_b32 a17, 0
    v_accvgpr_write_b32 a18, 0
    v_accvgpr_write_b32 a19, 0
    v_accvgpr_write_b32 a20, 0
    v_accvgpr_write_b32 a21, 0
    v_accvgpr_write_b32 a22, 0
    v_accvgpr_write_b32 a23, 0
    v_accvgpr_write_b32 a24, 0
    v_accvgpr_write_b32 a25, 0
    v_accvgpr_write_b32 a26, 0
    v_accvgpr_write_b32 a27, 0
    v_accvgpr_write_b32 a28, 0
    v_accvgpr_write_b32 a29, 0
    v_accvgpr_write_b32 a30, 0
    v_accvgpr_write_b32 a31, 0
    v_accvgpr_write_b32 a32, 0
    v_accvgpr_write_b32 a33, 0
    v_accvgpr_write_b32 a34, 0
    v_accvgpr_write_b32 a35, 0
    v_accvgpr_write_b32 a36, 0
    v_accvgpr_write_b32 a37, 0
    v_accvgpr_write_b32 a38, 0
    v_accvgpr_write_b32 a39, 0
    v_accvgpr_write_b32 a40, 0
    v_accvgpr_write_b32 a41, 0
    v_accvgpr_write_b32 a42, 0
    v_accvgpr_write_b32 a43, 0
    v_accvgpr_write_b32 a44, 0
    v_accvgpr_write_b32 a45, 0
    v_accvgpr_write_b32 a46, 0
    v_accvgpr_write_b32 a47, 0
    v_accvgpr_write_b32 a48, 0
    v_accvgpr_write_b32 a49, 0
    v_accvgpr_write_b32 a50, 0
    v_accvgpr_write_b32 a51, 0
    v_accvgpr_write_b32 a52, 0
    v_accvgpr_write_b32 a53, 0
    v_accvgpr_write_b32 a54, 0
    v_accvgpr_write_b32 a55, 0
    v_accvgpr_write_b32 a56, 0
    v_accvgpr_write_b32 a57, 0
    v_accvgpr_write_b32 a58, 0
    v_accvgpr_write_b32 a59, 0
    v_accvgpr_write_b32 a60, 0
    v_accvgpr_write_b32 a61, 0
    v_accvgpr_write_b32 a62, 0
    v_accvgpr_write_b32 a63, 0
    v_accvgpr_write_b32 a64, 0
    v_accvgpr_write_b32 a65, 0
    v_accvgpr_write_b32 a66, 0
    v_accvgpr_write_b32 a67, 0
    v_accvgpr_write_b32 a68, 0
    v_accvgpr_write_b32 a69, 0
    v_accvgpr_write_b32 a70, 0
    v_accvgpr_write_b32 a71, 0
    v_accvgpr_write_b32 a72, 0
    v_accvgpr_write_b32 a73, 0
    v_accvgpr_write_b32 a74, 0
    v_accvgpr_write_b32 a75, 0
    v_accvgpr_write_b32 a76, 0
    v_accvgpr_write_b32 a77, 0
    v_accvgpr_write_b32 a78, 0
    v_accvgpr_write_b32 a79, 0
    v_accvgpr_write_b32 a80, 0
    v_accvgpr_write_b32 a81, 0
    v_accvgpr_write_b32 a82, 0
    v_accvgpr_write_b32 a83, 0
    v_accvgpr_write_b32 a84, 0
    v_accvgpr_write_b32 a85, 0
    v_accvgpr_write_b32 a86, 0
    v_accvgpr_write_b32 a87, 0
    v_accvgpr_write_b32 a88, 0
    v_accvgpr_write_b32 a89, 0
    v_accvgpr_write_b32 a90, 0
    v_accvgpr_write_b32 a91, 0
    v_accvgpr_write_b32 a92, 0
    v_accvgpr_write_b32 a93, 0
    v_accvgpr_write_b32 a94, 0
    v_accvgpr_write_b32 a95, 0
    v_accvgpr_write_b32 a96, 0
    v_accvgpr_write_b32 a97, 0
    v_accvgpr_write_b32 a98, 0
    v_accvgpr_write_b32 a99, 0
    v_accvgpr_write_b32 a100, 0
    v_accvgpr_write_b32 a101, 0
    v_accvgpr_write_b32 a102, 0
    v_accvgpr_write_b32 a103, 0
    v_accvgpr_write_b32 a104, 0
    v_accvgpr_write_b32 a105, 0
    v_accvgpr_write_b32 a106, 0
    v_accvgpr_write_b32 a107, 0
    v_accvgpr_write_b32 a108, 0
    v_accvgpr_write_b32 a109, 0
    v_accvgpr_write_b32 a110, 0
    v_accvgpr_write_b32 a111, 0
    v_accvgpr_write_b32 a112, 0
    v_accvgpr_write_b32 a113, 0
    v_accvgpr_write_b32 a114, 0
    v_accvgpr_write_b32 a115, 0
    v_accvgpr_write_b32 a116, 0
    v_accvgpr_write_b32 a117, 0
    v_accvgpr_write_b32 a118, 0
    v_accvgpr_write_b32 a119, 0
    v_accvgpr_write_b32 a120, 0
    v_accvgpr_write_b32 a121, 0
    v_accvgpr_write_b32 a122, 0
    v_accvgpr_write_b32 a123, 0
    v_accvgpr_write_b32 a124, 0
    v_accvgpr_write_b32 a125, 0
    v_accvgpr_write_b32 a126, 0
    v_accvgpr_write_b32 a127, 0
    v_mov_b32 v200, 0
    ds_read_b128 v[96:99], v160 offset:0
    ds_read_b128 v[100:103], v161 offset:0
    ds_read_b128 v[104:107], v162 offset:0
    ds_read_b128 v[108:111], v163 offset:0
    ds_read_b128 v[112:115], v164 offset:0
    ds_read_b128 v[116:119], v165 offset:0
    ds_read_b128 v[120:123], v166 offset:0
    ds_read_b128 v[124:127], v167 offset:0
    s_waitcnt lgkmcnt(6)
    v_mfma_f32_32x32x16_bf16 v[0:15], v[96:99], a[128:131], 0
    ds_read_b128 v[96:99], v160 offset:256
    v_mfma_f32_32x32x16_bf16 v[0:15], v[100:103], a[132:135], v[0:15]
    ds_read_b128 v[100:103], v161 offset:256
    s_waitcnt lgkmcnt(6)
    v_mfma_f32_32x32x16_bf16 v[0:15], v[104:107], a[136:139], v[0:15]
    ds_read_b128 v[104:107], v162 offset:256
    v_mfma_f32_32x32x16_bf16 v[0:15], v[108:111], a[140:143], v[0:15]
    ds_read_b128 v[108:111], v163 offset:256
    s_waitcnt lgkmcnt(6)
    v_mfma_f32_32x32x16_bf16 v[0:15], v[112:115], a[144:147], v[0:15]
    ds_read_b128 v[112:115], v164 offset:256
    v_mfma_f32_32x32x16_bf16 v[0:15], v[116:119], a[148:151], v[0:15]
    ds_read_b128 v[116:119], v165 offset:256
    s_waitcnt lgkmcnt(6)
    v_mfma_f32_32x32x16_bf16 v[0:15], v[120:123], a[152:155], v[0:15]
    ds_read_b128 v[120:123], v166 offset:256
    v_mfma_f32_32x32x16_bf16 v[0:15], v[124:127], a[156:159], v[0:15]
    ds_read_b128 v[124:127], v167 offset:256
    s_waitcnt lgkmcnt(6)
    v_mfma_f32_32x32x16_bf16 v[0:15], v[96:99], a[160:163], v[0:15]
    ds_read_b128 v[96:99], v160 offset:16384
    v_mfma_f32_32x32x16_bf16 v[0:15], v[100:103], a[164:167], v[0:15]
    ds_read_b128 v[100:103], v161 offset:16384
    s_waitcnt lgkmcnt(6)
    v_mfma_f32_32x32x16_bf16 v[0:15], v[104:107], a[168:171], v[0:15]
    ds_read_b128 v[104:107], v162 offset:16384
    v_mfma_f32_32x32x16_bf16 v[0:15], v[108:111], a[172:175], v[0:15]
    ds_read_b128 v[108:111], v163 offset:16384
    s_waitcnt lgkmcnt(6)
    v_mfma_f32_32x32x16_bf16 v[0:15], v[112:115], a[176:179], v[0:15]
    ds_read_b128 v[112:115], v164 offset:16384
    v_mfma_f32_32x32x16_bf16 v[0:15], v[116:119], a[180:183], v[0:15]
    ds_read_b128 v[116:119], v165 offset:16384
    s_waitcnt lgkmcnt(6)
    v_mfma_f32_32x32x16_bf16 v[0:15], v[120:123], a[184:187], v[0:15]
    ds_read_b128 v[120:123], v166 offset:16384
    v_mfma_f32_32x32x16_bf16 v[0:15], v[124:127], a[188:191], v[0:15]
    ds_read_b128 v[124:127], v167 offset:16384
    s_waitcnt lgkmcnt(6)
    v_mfma_f32_32x32x16_bf16 v[16:31], v[96:99], a[128:131], 0
    ds_read_b128 v[96:99], v160 offset:16640
    v_mfma_f32_32x32x16_bf16 v[16:31], v[100:103], a[132:135], v[16:31]
    ds_read_b128 v[100:103], v161 offset:16640
    s_waitcnt lgkmcnt(6)
    v_mfma_f32_32x32x16_bf16 v[16:31], v[104:107], a[136:139], v[16:31]
    ds_read_b128 v[104:107], v162 offset:16640
    v_mfma_f32_32x32x16_bf16 v[16:31], v[108:111], a[140:143], v[16:31]
    ds_read_b128 v[108:111], v163 offset:16640
    s_waitcnt lgkmcnt(6)
    v_mfma_f32_32x32x16_bf16 v[16:31], v[112:115], a[144:147], v[16:31]
    ds_read_b128 v[112:115], v164 offset:16640
    v_mfma_f32_32x32x16_bf16 v[16:31], v[116:119], a[148:151], v[16:31]
    ds_read_b128 v[116:119], v165 offset:16640
    s_waitcnt lgkmcnt(6)
    v_mfma_f32_32x32x16_bf16 v[16:31], v[120:123], a[152:155], v[16:31]
    ds_read_b128 v[120:123], v166 offset:16640
    v_mfma_f32_32x32x16_bf16 v[16:31], v[124:127], a[156:159], v[16:31]
    ds_read_b128 v[124:127], v167 offset:16640
    s_waitcnt lgkmcnt(6)
    v_mfma_f32_32x32x16_bf16 v[16:31], v[96:99], a[160:163], v[16:31]
    v_mfma_f32_32x32x16_bf16 v[16:31], v[100:103], a[164:167], v[16:31]
    s_waitcnt lgkmcnt(4)
    v_mfma_f32_32x32x16_bf16 v[16:31], v[104:107], a[168:171], v[16:31]
    v_mfma_f32_32x32x16_bf16 v[16:31], v[108:111], a[172:175], v[16:31]
    s_waitcnt lgkmcnt(2)
    v_mfma_f32_32x32x16_bf16 v[16:31], v[112:115], a[176:179], v[16:31]
    v_mfma_f32_32x32x16_bf16 v[16:31], v[116:119], a[180:183], v[16:31]
    s_waitcnt lgkmcnt(0)
    v_mfma_f32_32x32x16_bf16 v[16:31], v[120:123], a[184:187], v[16:31]
    v_mfma_f32_32x32x16_bf16 v[16:31], v[124:127], a[188:191], v[16:31]
    s_lshl_b32 s57, s51, 6
    v_subrev_u32 v208, s57, v207
    s_nop 7
    s_nop 3
    v_cmp_lt_i32 s[42:43], v208, 0
    v_cmp_lt_i32 s[44:45], v208, 1
    v_cmp_lt_i32 s[46:47], v208, 2
    v_cmp_lt_i32 s[48:49], v208, 3
    v_cndmask_b32 v0, v0, v209, s[42:43]
    v_cndmask_b32 v1, v1, v209, s[44:45]
    v_cndmask_b32 v2, v2, v209, s[46:47]
    v_cndmask_b32 v3, v3, v209, s[48:49]
    v_cmp_lt_i32 s[42:43], v208, 8
    v_cmp_lt_i32 s[44:45], v208, 9
    v_cmp_lt_i32 s[46:47], v208, 10
    v_cmp_lt_i32 s[48:49], v208, 11
    v_cndmask_b32 v4, v4, v209, s[42:43]
    v_cndmask_b32 v5, v5, v209, s[44:45]
    v_cndmask_b32 v6, v6, v209, s[46:47]
    v_cndmask_b32 v7, v7, v209, s[48:49]
    v_cmp_lt_i32 s[42:43], v208, 16
    v_cmp_lt_i32 s[44:45], v208, 17
    v_cmp_lt_i32 s[46:47], v208, 18
    v_cmp_lt_i32 s[48:49], v208, 19
    v_cndmask_b32 v8, v8, v209, s[42:43]
    v_cndmask_b32 v9, v9, v209, s[44:45]
    v_cndmask_b32 v10, v10, v209, s[46:47]
    v_cndmask_b32 v11, v11, v209, s[48:49]
    v_cmp_lt_i32 s[42:43], v208, 24
    v_cmp_lt_i32 s[44:45], v208, 25
    v_cmp_lt_i32 s[46:47], v208, 26
    v_cmp_lt_i32 s[48:49], v208, 27
    v_cndmask_b32 v12, v12, v209, s[42:43]
    v_cndmask_b32 v13, v13, v209, s[44:45]
    v_cndmask_b32 v14, v14, v209, s[46:47]
    v_cndmask_b32 v15, v15, v209, s[48:49]
    v_cmp_lt_i32 s[42:43], v208, 32
    v_cmp_lt_i32 s[44:45], v208, 33
    v_cmp_lt_i32 s[46:47], v208, 34
    v_cmp_lt_i32 s[48:49], v208, 35
    v_cndmask_b32 v16, v16, v209, s[42:43]
    v_cndmask_b32 v17, v17, v209, s[44:45]
    v_cndmask_b32 v18, v18, v209, s[46:47]
    v_cndmask_b32 v19, v19, v209, s[48:49]
    v_cmp_lt_i32 s[42:43], v208, 40
    v_cmp_lt_i32 s[44:45], v208, 41
    v_cmp_lt_i32 s[46:47], v208, 42
    v_cmp_lt_i32 s[48:49], v208, 43
    v_cndmask_b32 v20, v20, v209, s[42:43]
    v_cndmask_b32 v21, v21, v209, s[44:45]
    v_cndmask_b32 v22, v22, v209, s[46:47]
    v_cndmask_b32 v23, v23, v209, s[48:49]
    v_cmp_lt_i32 s[42:43], v208, 48
    v_cmp_lt_i32 s[44:45], v208, 49
    v_cmp_lt_i32 s[46:47], v208, 50
    v_cmp_lt_i32 s[48:49], v208, 51
    v_cndmask_b32 v24, v24, v209, s[42:43]
    v_cndmask_b32 v25, v25, v209, s[44:45]
    v_cndmask_b32 v26, v26, v209, s[46:47]
    v_cndmask_b32 v27, v27, v209, s[48:49]
    v_cmp_lt_i32 s[42:43], v208, 56
    v_cmp_lt_i32 s[44:45], v208, 57
    v_cmp_lt_i32 s[46:47], v208, 58
    v_cmp_lt_i32 s[48:49], v208, 59
    v_cndmask_b32 v28, v28, v209, s[42:43]
    v_cndmask_b32 v29, v29, v209, s[44:45]
    v_cndmask_b32 v30, v30, v209, s[46:47]
    v_cndmask_b32 v31, v31, v209, s[48:49]
    v_max3_f32 v201, v0, v1, v2
    v_max3_f32 v211, v3, v4, v5
    v_max3_f32 v201, v201, v6, v7
    v_max3_f32 v211, v211, v8, v9
    v_max3_f32 v201, v201, v10, v11
    v_max3_f32 v211, v211, v12, v13
    v_max3_f32 v201, v201, v14, v15
    v_max3_f32 v211, v211, v16, v17
    v_max3_f32 v201, v201, v18, v19
    v_max3_f32 v211, v211, v20, v21
    v_max3_f32 v201, v201, v22, v23
    v_max3_f32 v211, v211, v24, v25
    v_max3_f32 v201, v201, v26, v27
    v_max3_f32 v211, v211, v28, v29
    v_max3_f32 v201, v201, v30, v31
    v_max_f32 v201, v201, v211
    v_mov_b32 v211, v201
    s_nop 1
    v_permlane32_swap_b32 v201, v211
    v_max_f32 v201, v201, v211
    v_mul_f32 v202, s28, v201
    v_sub_f32 v202, 0, v202
    v_fma_f32 v184, v0, s28, v202
    v_fma_f32 v185, v1, s28, v202
    v_fma_f32 v186, v2, s28, v202
    v_fma_f32 v187, v3, s28, v202
    v_exp_f32 v184, v184
    v_exp_f32 v185, v185
    v_fma_f32 v188, v4, s28, v202
    v_fma_f32 v189, v5, s28, v202
    v_exp_f32 v186, v186
    v_exp_f32 v187, v187
    v_mov_b32 v203, v184
    v_mov_b32 v204, v185
    v_cvt_pk_bf16_f32 v64, v184, v185
    v_fma_f32 v190, v6, s28, v202
    v_fma_f32 v191, v7, s28, v202
    v_exp_f32 v188, v188
    v_exp_f32 v189, v189
    v_add_f32 v203, v203, v186
    v_add_f32 v204, v204, v187
    v_cvt_pk_bf16_f32 v65, v186, v187
    v_fma_f32 v184, v8, s28, v202
    v_fma_f32 v185, v9, s28, v202
    v_exp_f32 v190, v190
    v_exp_f32 v191, v191
    v_add_f32 v203, v203, v188
    v_add_f32 v204, v204, v189
    v_cvt_pk_bf16_f32 v66, v188, v189
    v_fma_f32 v186, v10, s28, v202
    v_fma_f32 v187, v11, s28, v202
    v_exp_f32 v184, v184
    v_exp_f32 v185, v185
    v_add_f32 v203, v203, v190
    v_add_f32 v204, v204, v191
    v_cvt_pk_bf16_f32 v67, v190, v191
    v_exp_f32 v186, v186
    v_exp_f32 v187, v187
    v_add_f32 v203, v203, v184
    v_add_f32 v204, v204, v185
    v_cvt_pk_bf16_f32 v68, v184, v185
    v_add_f32 v203, v203, v186
    v_add_f32 v204, v204, v187
    v_cvt_pk_bf16_f32 v69, v186, v187
    s_cmp_eq_u32 s68, 1
    s_cbranch_scc1 .Lpro1
    s_waitcnt vmcnt(0)
    s_cmp_eq_u32 s69, 1
    s_cbranch_scc0 .Lpro1
    s_lshl_b32 s57, s59, 2
    s_add_u32 s57, s57, s60
    s_and_b32 s63, s57, 31
    s_lshr_b32 s57, s57, 5
    s_lshl_b32 s57, s57, 2
    s_add_u32 s57, s57, 64
    v_mov_b32 v213, s57
    s_lshl_b32 s58, 1, s63
    v_mov_b32 v217, s58
    s_mov_b64 exec, 1
    buffer_atomic_or v217, v213, s[24:27], 0 offen sc1
    s_mov_b64 exec, -1
.Lpro1:
    s_waitcnt vmcnt(6) lgkmcnt(0)
    s_barrier
    s_cmp_eq_u32 s38, 2
    s_cbranch_scc0 .Lpro2
    buffer_load_dwordx4 a[192:195], v214, s[4:7], s53 offen offset:0
    buffer_load_dwordx4 a[196:199], v214, s[4:7], s53 offen offset:32
    buffer_load_dwordx4 a[200:203], v214, s[4:7], s53 offen offset:64
    buffer_load_dwordx4 a[204:207], v214, s[4:7], s53 offen offset:96
    buffer_load_dwordx4 a[208:211], v214, s[4:7], s53 offen offset:128
    buffer_load_dwordx4 a[212:215], v214, s[4:7], s53 offen offset:160
    buffer_load_dwordx4 a[216:219], v214, s[4:7], s53 offen offset:192
    buffer_load_dwordx4 a[220:223], v214, s[4:7], s53 offen offset:224
    buffer_load_dwordx4 a[224:227], v214, s[4:7], s53 offen offset:256
    buffer_load_dwordx4 a[228:231], v214, s[4:7], s53 offen offset:288
    buffer_load_dwordx4 a[232:235], v214, s[4:7], s53 offen offset:320
    buffer_load_dwordx4 a[236:239], v214, s[4:7], s53 offen offset:352
    buffer_load_dwordx4 a[240:243], v214, s[4:7], s53 offen offset:384
    buffer_load_dwordx4 a[244:247], v214, s[4:7], s53 offen offset:416
    buffer_load_dwordx4 a[248:251], v214, s[4:7], s53 offen offset:448
    buffer_load_dwordx4 a[252:255], v214, s[4:7], s53 offen offset:480
.Lpro2:
    ds_read_b128 v[96:99], v160 offset:32768
    ds_read_b128 v[100:103], v161 offset:32768
    ds_read_b128 v[104:107], v162 offset:32768
    ds_read_b128 v[108:111], v163 offset:32768
    ds_read_b128 v[112:115], v164 offset:32768
    ds_read_b128 v[116:119], v165 offset:32768
    ds_read_b128 v[120:123], v166 offset:32768
    ds_read_b128 v[124:127], v167 offset:32768
    s_add_u32 m0, s29, 98304
    s_nop 0
    buffer_load_dwordx4 v180, s[12:15], s31 offen offset:0 lds
    buffer_load_dwordx4 v181, s[12:15], s31 offen offset:1024 lds
    buffer_load_dwordx4 v180, s[12:15], s31 offen offset:2048 lds
    v_mov_b32 v227, 0
    s_mov_b32 s63, 0
    s_cmp_eq_u32 s52, 2
    s_cbranch_scc1 .Lt0m
    s_sub_u32 s36, s52, 2
    s_lshr_b32 s36, s36, 1
.Lloop:
    s_waitcnt lgkmcnt(6)
    v_mfma_f32_32x32x16_bf16 v[32:47], v[96:99], a[128:131], 0
    ds_read_b128 v[96:99], v160 offset:33024
    buffer_load_dwordx4 v181, s[12:15], s31 offen offset:3072 lds
    v_fma_f32 v184, v12, s28, v202
    v_fma_f32 v185, v13, s28, v202
    v_mfma_f32_32x32x16_bf16 v[32:47], v[100:103], a[132:135], v[32:47]
    ds_read_b128 v[100:103], v161 offset:33024
    v_fma_f32 v186, v14, s28, v202
    v_fma_f32 v187, v15, s28, v202
    v_exp_f32 v184, v184
    s_waitcnt lgkmcnt(6)
    v_mfma_f32_32x32x16_bf16 v[32:47], v[104:107], a[136:139], v[32:47]
    ds_read_b128 v[104:107], v162 offset:33024
    s_add_u32 m0, s29, 102400
    s_nop 0
    buffer_load_dwordx4 v182, s[12:15], s31 offen offset:0 lds
    v_exp_f32 v185, v185
    v_mfma_f32_32x32x16_bf16 v[32:47], v[108:111], a[140:143], v[32:47]
    ds_read_b128 v[108:111], v163 offset:33024
    v_fma_f32 v188, v16, s28, v202
    v_fma_f32 v189, v17, s28, v202
    v_exp_f32 v186, v186
    s_waitcnt lgkmcnt(6)
    v_mfma_f32_32x32x16_bf16 v[32:47], v[112:115], a[144:147], v[32:47]
    ds_read_b128 v[112:115], v164 offset:33024
    buffer_load_dwordx4 v183, s[12:15], s31 offen offset:1024 lds
    v_exp_f32 v187, v187
    v_mfma_f32_32x32x16_bf16 v[32:47], v[116:119], a[148:151], v[32:47]
    ds_read_b128 v[116:119], v165 offset:33024
    v_add_f32 v203, v203, v184
    v_add_f32 v204, v204, v185
    v_cvt_pk_bf16_f32 v70, v184, v185
    v_fma_f32 v190, v18, s28, v202
    v_fma_f32 v191, v19, s28, v202
    s_waitcnt lgkmcnt(6)
    v_mfma_f32_32x32x16_bf16 v[32:47], v[120:123], a[152:155], v[32:47]
    ds_read_b128 v[120:123], v166 offset:33024
    buffer_load_dwordx4 v182, s[12:15], s31 offen offset:2048 lds
    v_exp_f32 v188, v188
    v_mfma_f32_32x32x16_bf16 v[32:47], v[124:127], a[156:159], v[32:47]
    ds_read_b128 v[124:127], v167 offset:33024
    v_exp_f32 v189, v189
    v_add_f32 v203, v203, v186
    v_add_f32 v204, v204, v187
    s_waitcnt lgkmcnt(6)
    v_mfma_f32_32x32x16_bf16 v[32:47], v[96:99], a[160:163], v[32:47]
    ds_read_b128 v[96:99], v160 offset:49152
    buffer_load_dwordx4 v183, s[12:15], s31 offen offset:3072 lds
    v_cvt_pk_bf16_f32 v71, v186, v187
    v_fma_f32 v184, v20, s28, v202
    v_fma_f32 v185, v21, s28, v202
    v_mfma_f32_32x32x16_bf16 v[32:47], v[100:103], a[164:167], v[32:47]
    ds_read_b128 v[100:103], v161 offset:49152
    v_exp_f32 v190, v190
    v_exp_f32 v191, v191
    s_waitcnt lgkmcnt(6)
    v_mfma_f32_32x32x16_bf16 v[32:47], v[104:107], a[168:171], v[32:47]
    ds_read_b128 v[104:107], v162 offset:49152
    s_add_u32 m0, s29, 0
    s_nop 0
    buffer_load_dwordx4 v172, s[8:11], s30 offen offset:0 lds
    v_add_f32 v203, v203, v188
    v_mfma_f32_32x32x16_bf16 v[32:47], v[108:111], a[172:175], v[32:47]
    ds_read_b128 v[108:111], v163 offset:49152
    v_add_f32 v204, v204, v189
    v_cvt_pk_bf16_f32 v72, v188, v189
    v_fma_f32 v186, v22, s28, v202
    v_fma_f32 v187, v23, s28, v202
    s_waitcnt lgkmcnt(6)
    v_mfma_f32_32x32x16_bf16 v[32:47], v[112:115], a[176:179], v[32:47]
    ds_read_b128 v[112:115], v164 offset:49152
    buffer_load_dwordx4 v173, s[8:11], s30 offen offset:1024 lds
    v_exp_f32 v184, v184
    v_mfma_f32_32x32x16_bf16 v[32:47], v[116:119], a[180:183], v[32:47]
    ds_read_b128 v[116:119], v165 offset:49152
    v_exp_f32 v185, v185
    v_add_f32 v203, v203, v190
    v_add_f32 v204, v204, v191
    v_cvt_pk_bf16_f32 v73, v190, v191
    s_waitcnt lgkmcnt(6)
    v_mfma_f32_32x32x16_bf16 v[32:47], v[120:123], a[184:187], v[32:47]
    ds_read_b128 v[120:123], v166 offset:49152
    buffer_load_dwordx4 v174, s[8:11], s30 offen offset:2048 lds
    v_fma_f32 v188, v24, s28, v202
    v_fma_f32 v189, v25, s28, v202
    v_mfma_f32_32x32x16_bf16 v[32:47], v[124:127], a[188:191], v[32:47]
    ds_read_b128 v[124:127], v167 offset:49152
    v_exp_f32 v186, v186
    v_exp_f32 v187, v187
    s_waitcnt lgkmcnt(6)
    v_mfma_f32_32x32x16_bf16 v[48:63], v[96:99], a[128:131], 0
    ds_read_b128 v[96:99], v160 offset:49408
    buffer_load_dwordx4 v175, s[8:11], s30 offen offset:3072 lds
    v_add_f32 v203, v203, v184
    v_add_f32 v204, v204, v185
    v_cvt_pk_bf16_f32 v74, v184, v185
    v_mfma_f32_32x32x16_bf16 v[48:63], v[100:103], a[132:135], v[48:63]
    ds_read_b128 v[100:103], v161 offset:49408
    v_fma_f32 v190, v26, s28, v202
    v_fma_f32 v191, v27, s28, v202
    v_exp_f32 v188, v188
    s_waitcnt lgkmcnt(6)
    v_mfma_f32_32x32x16_bf16 v[48:63], v[104:107], a[136:139], v[48:63]
    ds_read_b128 v[104:107], v162 offset:49408
    s_add_u32 m0, s29, 4096
    s_nop 0
    buffer_load_dwordx4 v176, s[8:11], s30 offen offset:0 lds
    v_exp_f32 v189, v189
    v_mfma_f32_32x32x16_bf16 v[48:63], v[108:111], a[140:143], v[48:63]
    ds_read_b128 v[108:111], v163 offset:49408
    v_add_f32 v203, v203, v186
    v_add_f32 v204, v204, v187
    v_cvt_pk_bf16_f32 v75, v186, v187
    s_waitcnt lgkmcnt(6)
    v_mfma_f32_32x32x16_bf16 v[48:63], v[112:115], a[144:147], v[48:63]
    ds_read_b128 v[112:115], v164 offset:49408
    buffer_load_dwordx4 v177, s[8:11], s30 offen offset:1024 lds
    v_fma_f32 v184, v28, s28, v202
    v_fma_f32 v185, v29, s28, v202
    v_mfma_f32_32x32x16_bf16 v[48:63], v[116:119], a[148:151], v[48:63]
    ds_read_b128 v[116:119], v165 offset:49408
    v_exp_f32 v190, v190
    v_exp_f32 v191, v191
    v_add_f32 v203, v203, v188
    s_waitcnt lgkmcnt(6)
    v_mfma_f32_32x32x16_bf16 v[48:63], v[120:123], a[152:155], v[48:63]
    ds_read_b128 v[120:123], v166 offset:49408
    buffer_load_dwordx4 v178, s[8:11], s30 offen offset:2048 lds
    v_add_f32 v204, v204, v189
    v_cvt_pk_bf16_f32 v76, v188, v189
    v_mfma_f32_32x32x16_bf16 v[48:63], v[124:127], a[156:159], v[48:63]
    ds_read_b128 v[124:127], v167 offset:49408
    v_fma_f32 v186, v30, s28, v202
    v_fma_f32 v187, v31, s28, v202
    v_exp_f32 v184, v184
    s_waitcnt lgkmcnt(6)
    v_mfma_f32_32x32x16_bf16 v[48:63], v[96:99], a[160:163], v[48:63]
    buffer_load_dwordx4 v179, s[8:11], s30 offen offset:3072 lds
    v_exp_f32 v185, v185
    v_add_f32 v203, v203, v190
    v_add_f32 v204, v204, v191
    v_mfma_f32_32x32x16_bf16 v[48:63], v[100:103], a[164:167], v[48:63]
    ds_read_b64_tr_b16 v[128:129], v168 offset:0
    ds_read_b64_tr_b16 v[130:131], v168 offset:4096
    v_cvt_pk_bf16_f32 v77, v190, v191
    v_exp_f32 v186, v186
    s_waitcnt lgkmcnt(6)
    v_mfma_f32_32x32x16_bf16 v[48:63], v[104:107], a[168:171], v[48:63]
    s_mov_b32 s31, s30
    s_add_u32 s30, s30, 0x8000
    s_cmp_eq_u32 s30, s32
    s_cselect_b32 s30, s33, s30
    s_cmp_eq_u32 s30, s34
    s_cselect_b32 s30, s35, s30
    ds_read_b64_tr_b16 v[132:133], v169 offset:0
    ds_read_b64_tr_b16 v[134:135], v169 offset:4096
    v_mfma_f32_32x32x16_bf16 v[48:63], v[108:111], a[172:175], v[48:63]
    ds_read_b64_tr_b16 v[136:137], v170 offset:0
    ds_read_b64_tr_b16 v[138:139], v170 offset:4096
    v_exp_f32 v187, v187
    v_add_f32 v203, v203, v184
    s_waitcnt lgkmcnt(8)
    v_mfma_f32_32x32x16_bf16 v[48:63], v[112:115], a[176:179], v[48:63]
    buffer_load_dword v220, v219, s[12:15], s66 offen
    ds_read_b64_tr_b16 v[140:141], v171 offset:0
    ds_read_b64_tr_b16 v[142:143], v171 offset:4096
    v_add_f32 v204, v204, v185
    v_cvt_pk_bf16_f32 v78, v184, v185
    v_mfma_f32_32x32x16_bf16 v[48:63], v[116:119], a[180:183], v[48:63]
    ds_read_b64_tr_b16 v[144:145], v168 offset:256
    ds_read_b64_tr_b16 v[146:147], v168 offset:4352
    v_add_f32 v203, v203, v186
    v_add_f32 v204, v204, v187
    v_cvt_pk_bf16_f32 v79, v186, v187
    s_waitcnt lgkmcnt(10)
    v_mfma_f32_32x32x16_bf16 v[48:63], v[120:123], a[184:187], v[48:63]
    buffer_load_dword v221, v219, s[8:11], s66 offen
    ds_read_b64_tr_b16 v[148:149], v169 offset:256
    ds_read_b64_tr_b16 v[150:151], v169 offset:4352
    v_mfma_f32_32x32x16_bf16 v[48:63], v[124:127], a[188:191], v[48:63]
    s_add_u32 s66, s66, 0x8000
    v_add_f32 v203, v203, v204
    v_cmp_nle_f32 vcc, v203, v218
    s_nop 3
    s_cbranch_vccz .Lok_i0
    s_getpc_b64 s[40:41]
    s_branch .Lrare0
.Lok_i0:
    v_add_f32 v200, v200, v203
    s_waitcnt lgkmcnt(8)
    v_mfma_f32_32x32x16_bf16 a[0:15], v[128:131], v[64:67], a[0:15]
    ds_read_b64_tr_b16 v[152:153], v170 offset:256
    ds_read_b64_tr_b16 v[154:155], v170 offset:4352
    v_mfma_f32_32x32x16_bf16 a[16:31], v[132:135], v[64:67], a[16:31]
    ds_read_b64_tr_b16 v[156:157], v171 offset:256
    ds_read_b64_tr_b16 v[158:159], v171 offset:4352
    v_fma_f32 v184, v32, s28, v202
    v_fma_f32 v185, v33, s28, v202
    s_waitcnt lgkmcnt(8)
    v_mfma_f32_32x32x16_bf16 a[32:47], v[136:139], v[64:67], a[32:47]
    ds_read_b64_tr_b16 v[128:129], v168 offset:8192
    ds_read_b64_tr_b16 v[130:131], v168 offset:12288
    v_fma_f32 v186, v34, s28, v202
    v_fma_f32 v187, v35, s28, v202
    v_mfma_f32_32x32x16_bf16 a[48:63], v[140:143], v[64:67], a[48:63]
    ds_read_b64_tr_b16 v[132:133], v169 offset:8192
    ds_read_b64_tr_b16 v[134:135], v169 offset:12288
    v_exp_f32 v184, v184
    s_waitcnt lgkmcnt(8)
    v_mfma_f32_32x32x16_bf16 a[64:79], v[144:147], v[64:67], a[64:79]
    ds_read_b64_tr_b16 v[136:137], v170 offset:8192
    ds_read_b64_tr_b16 v[138:139], v170 offset:12288
    v_exp_f32 v185, v185
    v_mfma_f32_32x32x16_bf16 a[80:95], v[148:151], v[64:67], a[80:95]
    ds_read_b64_tr_b16 v[140:141], v171 offset:8192
    ds_read_b64_tr_b16 v[142:143], v171 offset:12288
    v_fma_f32 v188, v36, s28, v202
    v_fma_f32 v189, v37, s28, v202
    s_waitcnt lgkmcnt(8)
    v_mfma_f32_32x32x16_bf16 a[96:111], v[152:155], v[64:67], a[96:111]
    ds_read_b64_tr_b16 v[144:145], v168 offset:8448
    ds_read_b64_tr_b16 v[146:147], v168 offset:12544
    v_exp_f32 v186, v186
    v_mfma_f32_32x32x16_bf16 a[112:127], v[156:159], v[64:67], a[112:127]
    ds_read_b64_tr_b16 v[148:149], v169 offset:8448
    ds_read_b64_tr_b16 v[150:151], v169 offset:12544
    v_exp_f32 v187, v187
    s_waitcnt lgkmcnt(8)
    v_mfma_f32_32x32x16_bf16 a[0:15], v[128:131], v[68:71], a[0:15]
    ds_read_b64_tr_b16 v[152:153], v170 offset:8448
    ds_read_b64_tr_b16 v[154:155], v170 offset:12544
    v_mov_b32 v203, v184
    v_mfma_f32_32x32x16_bf16 a[16:31], v[132:135], v[68:71], a[16:31]
    ds_read_b64_tr_b16 v[156:157], v171 offset:8448
    ds_read_b64_tr_b16 v[158:159], v171 offset:12544
    v_mov_b32 v204, v185
    v_cvt_pk_bf16_f32 v80, v184, v185
    s_waitcnt lgkmcnt(8)
    v_mfma_f32_32x32x16_bf16 a[32:47], v[136:139], v[68:71], a[32:47]
    ds_read_b64_tr_b16 v[128:129], v168 offset:16384
    ds_read_b64_tr_b16 v[130:131], v168 offset:20480
    v_fma_f32 v190, v38, s28, v202
    v_fma_f32 v191, v39, s28, v202
    v_mfma_f32_32x32x16_bf16 a[48:63], v[140:143], v[68:71], a[48:63]
    ds_read_b64_tr_b16 v[132:133], v169 offset:16384
    ds_read_b64_tr_b16 v[134:135], v169 offset:20480
    v_exp_f32 v188, v188
    s_waitcnt lgkmcnt(8)
    v_mfma_f32_32x32x16_bf16 a[64:79], v[144:147], v[68:71], a[64:79]
    ds_read_b64_tr_b16 v[136:137], v170 offset:16384
    ds_read_b64_tr_b16 v[138:139], v170 offset:20480
    v_exp_f32 v189, v189
    v_mfma_f32_32x32x16_bf16 a[80:95], v[148:151], v[68:71], a[80:95]
    ds_read_b64_tr_b16 v[140:141], v171 offset:16384
    ds_read_b64_tr_b16 v[142:143], v171 offset:20480
    v_add_f32 v203, v203, v186
    v_add_f32 v204, v204, v187
    s_waitcnt lgkmcnt(8)
    v_mfma_f32_32x32x16_bf16 a[96:111], v[152:155], v[68:71], a[96:111]
    ds_read_b64_tr_b16 v[144:145], v168 offset:16640
    ds_read_b64_tr_b16 v[146:147], v168 offset:20736
    v_cvt_pk_bf16_f32 v81, v186, v187
    v_fma_f32 v184, v40, s28, v202
    v_mfma_f32_32x32x16_bf16 a[112:127], v[156:159], v[68:71], a[112:127]
    ds_read_b64_tr_b16 v[148:149], v169 offset:16640
    ds_read_b64_tr_b16 v[150:151], v169 offset:20736
    v_fma_f32 v185, v41, s28, v202
    s_waitcnt lgkmcnt(8)
    v_mfma_f32_32x32x16_bf16 a[0:15], v[128:131], v[72:75], a[0:15]
    ds_read_b64_tr_b16 v[152:153], v170 offset:16640
    ds_read_b64_tr_b16 v[154:155], v170 offset:20736
    v_exp_f32 v190, v190
    v_mfma_f32_32x32x16_bf16 a[16:31], v[132:135], v[72:75], a[16:31]
    ds_read_b64_tr_b16 v[156:157], v171 offset:16640
    ds_read_b64_tr_b16 v[158:159], v171 offset:20736
    v_exp_f32 v191, v191
    v_add_f32 v203, v203, v188
    s_waitcnt lgkmcnt(8)
    v_mfma_f32_32x32x16_bf16 a[32:47], v[136:139], v[72:75], a[32:47]
    ds_read_b64_tr_b16 v[128:129], v168 offset:24576
    ds_read_b64_tr_b16 v[130:131], v168 offset:28672
    v_add_f32 v204, v204, v189
    v_cvt_pk_bf16_f32 v82, v188, v189
    v_mfma_f32_32x32x16_bf16 a[48:63], v[140:143], v[72:75], a[48:63]
    ds_read_b64_tr_b16 v[132:133], v169 offset:24576
    ds_read_b64_tr_b16 v[134:135], v169 offset:28672
    v_fma_f32 v186, v42, s28, v202
    s_waitcnt lgkmcnt(8)
    v_mfma_f32_32x32x16_bf16 a[64:79], v[144:147], v[72:75], a[64:79]
    ds_read_b64_tr_b16 v[136:137], v170 offset:24576
    ds_read_b64_tr_b16 v[138:139], v170 offset:28672
    v_fma_f32 v187, v43, s28, v202
    v_exp_f32 v184, v184
    v_mfma_f32_32x32x16_bf16 a[80:95], v[148:151], v[72:75], a[80:95]
    ds_read_b64_tr_b16 v[140:141], v171 offset:24576
    ds_read_b64_tr_b16 v[142:143], v171 offset:28672
    v_exp_f32 v185, v185
    s_waitcnt lgkmcnt(8)
    v_mfma_f32_32x32x16_bf16 a[96:111], v[152:155], v[72:75], a[96:111]
    ds_read_b64_tr_b16 v[144:145], v168 offset:24832
    ds_read_b64_tr_b16 v[146:147], v168 offset:28928
    v_add_f32 v203, v203, v190
    v_mfma_f32_32x32x16_bf16 a[112:127], v[156:159], v[72:75], a[112:127]
    ds_read_b64_tr_b16 v[148:149], v169 offset:24832
    ds_read_b64_tr_b16 v[150:151], v169 offset:28928
    v_add_f32 v204, v204, v191
    v_cvt_pk_bf16_f32 v83, v190, v191
    s_waitcnt lgkmcnt(8)
    v_mfma_f32_32x32x16_bf16 a[0:15], v[128:131], v[76:79], a[0:15]
    ds_read_b64_tr_b16 v[152:153], v170 offset:24832
    ds_read_b64_tr_b16 v[154:155], v170 offset:28928
    v_exp_f32 v186, v186
    v_mfma_f32_32x32x16_bf16 a[16:31], v[132:135], v[76:79], a[16:31]
    ds_read_b64_tr_b16 v[156:157], v171 offset:24832
    ds_read_b64_tr_b16 v[158:159], v171 offset:28928
    v_exp_f32 v187, v187
    s_waitcnt lgkmcnt(8)
    v_mfma_f32_32x32x16_bf16 a[32:47], v[136:139], v[76:79], a[32:47]
    v_add_f32 v203, v203, v184
    v_add_f32 v204, v204, v185
    v_cvt_pk_bf16_f32 v84, v184, v185
    v_mfma_f32_32x32x16_bf16 a[48:63], v[140:143], v[76:79], a[48:63]
    v_add_f32 v203, v203, v186
    v_add_f32 v204, v204, v187
    v_cvt_pk_bf16_f32 v85, v186, v187
    s_waitcnt lgkmcnt(4)
    v_mfma_f32_32x32x16_bf16 a[64:79], v[144:147], v[76:79], a[64:79]
    s_waitcnt vmcnt(2) lgkmcnt(0)
    s_barrier
    ds_read_b128 v[96:99], v160 offset:0
    ds_read_b128 v[100:103], v161 offset:0
    s_add_u32 m0, s29, 65536
    v_mfma_f32_32x32x16_bf16 a[80:95], v[148:151], v[76:79], a[80:95]
    ds_read_b128 v[104:107], v162 offset:0
    ds_read_b128 v[108:111], v163 offset:0
    buffer_load_dwordx4 v180, s[12:15], s31 offen offset:0 lds
    v_mfma_f32_32x32x16_bf16 a[96:111], v[152:155], v[76:79], a[96:111]
    ds_read_b128 v[112:115], v164 offset:0
    ds_read_b128 v[116:119], v165 offset:0
    buffer_load_dwordx4 v181, s[12:15], s31 offen offset:1024 lds
    v_mfma_f32_32x32x16_bf16 a[112:127], v[156:159], v[76:79], a[112:127]
    ds_read_b128 v[120:123], v166 offset:0
    ds_read_b128 v[124:127], v167 offset:0
    buffer_load_dwordx4 v180, s[12:15], s31 offen offset:2048 lds
    s_sub_u32 s36, s36, 1
    s_cmp_eq_u32 s36, 0
    s_cbranch_scc1 .Lt1m_pre
    s_waitcnt lgkmcnt(6)
    v_mfma_f32_32x32x16_bf16 v[0:15], v[96:99], a[128:131], 0
    ds_read_b128 v[96:99], v160 offset:256
    buffer_load_dwordx4 v181, s[12:15], s31 offen offset:3072 lds
    v_fma_f32 v184, v44, s28, v202
    v_fma_f32 v185, v45, s28, v202
    v_mfma_f32_32x32x16_bf16 v[0:15], v[100:103], a[132:135], v[0:15]
    ds_read_b128 v[100:103], v161 offset:256
    v_fma_f32 v186, v46, s28, v202
    v_fma_f32 v187, v47, s28, v202
    v_exp_f32 v184, v184
    s_waitcnt lgkmcnt(6)
    v_mfma_f32_32x32x16_bf16 v[0:15], v[104:107], a[136:139], v[0:15]
    ds_read_b128 v[104:107], v162 offset:256
    s_add_u32 m0, s29, 69632
    s_nop 0
    buffer_load_dwordx4 v182, s[12:15], s31 offen offset:0 lds
    v_exp_f32 v185, v185
    v_mfma_f32_32x32x16_bf16 v[0:15], v[108:111], a[140:143], v[0:15]
    ds_read_b128 v[108:111], v163 offset:256
    v_fma_f32 v188, v48, s28, v202
    v_fma_f32 v189, v49, s28, v202
    v_exp_f32 v186, v186
    s_waitcnt lgkmcnt(6)
    v_mfma_f32_32x32x16_bf16 v[0:15], v[112:115], a[144:147], v[0:15]
    ds_read_b128 v[112:115], v164 offset:256
    buffer_load_dwordx4 v183, s[12:15], s31 offen offset:1024 lds
    v_exp_f32 v187, v187
    v_mfma_f32_32x32x16_bf16 v[0:15], v[116:119], a[148:151], v[0:15]
    ds_read_b128 v[116:119], v165 offset:256
    v_add_f32 v203, v203, v184
    v_add_f32 v204, v204, v185
    v_cvt_pk_bf16_f32 v86, v184, v185
    v_fma_f32 v190, v50, s28, v202
    v_fma_f32 v191, v51, s28, v202
    s_waitcnt lgkmcnt(6)
    v_mfma_f32_32x32x16_bf16 v[0:15], v[120:123], a[152:155], v[0:15]
    ds_read_b128 v[120:123], v166 offset:256
    buffer_load_dwordx4 v182, s[12:15], s31 offen offset:2048 lds
    v_exp_f32 v188, v188
    v_mfma_f32_32x32x16_bf16 v[0:15], v[124:127], a[156:159], v[0:15]
    ds_read_b128 v[124:127], v167 offset:256
    v_exp_f32 v189, v189
    v_add_f32 v203, v203, v186
    v_add_f32 v204, v204, v187
    s_waitcnt lgkmcnt(6)
    v_mfma_f32_32x32x16_bf16 v[0:15], v[96:99], a[160:163], v[0:15]
    ds_read_b128 v[96:99], v160 offset:16384
    buffer_load_dwordx4 v183, s[12:15], s31 offen offset:3072 lds
    v_cvt_pk_bf16_f32 v87, v186, v187
    v_fma_f32 v184, v52, s28, v202
    v_fma_f32 v185, v53, s28, v202
    v_mfma_f32_32x32x16_bf16 v[0:15], v[100:103], a[164:167], v[0:15]
    ds_read_b128 v[100:103], v161 offset:16384
    v_exp_f32 v190, v190
    v_exp_f32 v191, v191
    s_waitcnt lgkmcnt(6)
    v_mfma_f32_32x32x16_bf16 v[0:15], v[104:107], a[168:171], v[0:15]
    ds_read_b128 v[104:107], v162 offset:16384
    s_add_u32 m0, s29, 32768
    s_nop 0
    buffer_load_dwordx4 v172, s[8:11], s30 offen offset:0 lds
    v_add_f32 v203, v203, v188
    v_mfma_f32_32x32x16_bf16 v[0:15], v[108:111], a[172:175], v[0:15]
    ds_read_b128 v[108:111], v163 offset:16384
    v_add_f32 v204, v204, v189
    v_cvt_pk_bf16_f32 v88, v188, v189
    v_fma_f32 v186, v54, s28, v202
    v_fma_f32 v187, v55, s28, v202
    s_waitcnt lgkmcnt(6)
    v_mfma_f32_32x32x16_bf16 v[0:15], v[112:115], a[176:179], v[0:15]
    ds_read_b128 v[112:115], v164 offset:16384
    buffer_load_dwordx4 v173, s[8:11], s30 offen offset:1024 lds
    v_exp_f32 v184, v184
    v_mfma_f32_32x32x16_bf16 v[0:15], v[116:119], a[180:183], v[0:15]
    ds_read_b128 v[116:119], v165 offset:16384
    v_exp_f32 v185, v185
    v_add_f32 v203, v203, v190
    v_add_f32 v204, v204, v191
    v_cvt_pk_bf16_f32 v89, v190, v191
    s_waitcnt lgkmcnt(6)
    v_mfma_f32_32x32x16_bf16 v[0:15], v[120:123], a[184:187], v[0:15]
    ds_read_b128 v[120:123], v166 offset:16384
    buffer_load_dwordx4 v174, s[8:11], s30 offen offset:2048 lds
    v_fma_f32 v188, v56, s28, v202
    v_fma_f32 v189, v57, s28, v202
    v_mfma_f32_32x32x16_bf16 v[0:15], v[124:127], a[188:191], v[0:15]
    ds_read_b128 v[124:127], v167 offset:16384
    v_exp_f32 v186, v186
    v_exp_f32 v187, v187
    s_waitcnt lgkmcnt(6)
    v_mfma_f32_32x32x16_bf16 v[16:31], v[96:99], a[128:131], 0
    ds_read_b128 v[96:99], v160 offset:16640
    buffer_load_dwordx4 v175, s[8:11], s30 offen offset:3072 lds
    v_add_f32 v203, v203, v184
    v_add_f32 v204, v204, v185
    v_cvt_pk_bf16_f32 v90, v184, v185
    v_mfma_f32_32x32x16_bf16 v[16:31], v[100:103], a[132:135], v[16:31]
    ds_read_b128 v[100:103], v161 offset:16640
    v_fma_f32 v190, v58, s28, v202
    v_fma_f32 v191, v59, s28, v202
    v_exp_f32 v188, v188
    s_waitcnt lgkmcnt(6)
    v_mfma_f32_32x32x16_bf16 v[16:31], v[104:107], a[136:139], v[16:31]
    ds_read_b128 v[104:107], v162 offset:16640
    s_add_u32 m0, s29, 36864
    s_nop 0
    buffer_load_dwordx4 v176, s[8:11], s30 offen offset:0 lds
    v_exp_f32 v189, v189
    v_mfma_f32_32x32x16_bf16 v[16:31], v[108:111], a[140:143], v[16:31]
    ds_read_b128 v[108:111], v163 offset:16640
    v_add_f32 v203, v203, v186
    v_add_f32 v204, v204, v187
    v_cvt_pk_bf16_f32 v91, v186, v187
    s_waitcnt lgkmcnt(6)
    v_mfma_f32_32x32x16_bf16 v[16:31], v[112:115], a[144:147], v[16:31]
    ds_read_b128 v[112:115], v164 offset:16640
    buffer_load_dwordx4 v177, s[8:11], s30 offen offset:1024 lds
    v_fma_f32 v184, v60, s28, v202
    v_fma_f32 v185, v61, s28, v202
    v_mfma_f32_32x32x16_bf16 v[16:31], v[116:119], a[148:151], v[16:31]
    ds_read_b128 v[116:119], v165 offset:16640
    v_exp_f32 v190, v190
    v_exp_f32 v191, v191
    v_add_f32 v203, v203, v188
    s_waitcnt lgkmcnt(6)
    v_mfma_f32_32x32x16_bf16 v[16:31], v[120:123], a[152:155], v[16:31]
    ds_read_b128 v[120:123], v166 offset:16640
    buffer_load_dwordx4 v178, s[8:11], s30 offen offset:2048 lds
    v_add_f32 v204, v204, v189
    v_cvt_pk_bf16_f32 v92, v188, v189
    v_mfma_f32_32x32x16_bf16 v[16:31], v[124:127], a[156:159], v[16:31]
    ds_read_b128 v[124:127], v167 offset:16640
    v_fma_f32 v186, v62, s28, v202
    v_fma_f32 v187, v63, s28, v202
    v_exp_f32 v184, v184
    s_waitcnt lgkmcnt(6)
    v_mfma_f32_32x32x16_bf16 v[16:31], v[96:99], a[160:163], v[16:31]
    buffer_load_dwordx4 v179, s[8:11], s30 offen offset:3072 lds
    v_exp_f32 v185, v185
    v_add_f32 v203, v203, v190
    v_add_f32 v204, v204, v191
    v_mfma_f32_32x32x16_bf16 v[16:31], v[100:103], a[164:167], v[16:31]
    ds_read_b64_tr_b16 v[128:129], v168 offset:32768
    ds_read_b64_tr_b16 v[130:131], v168 offset:36864
    v_cvt_pk_bf16_f32 v93, v190, v191
    v_exp_f32 v186, v186
    s_waitcnt lgkmcnt(6)
    v_mfma_f32_32x32x16_bf16 v[16:31], v[104:107], a[168:171], v[16:31]
    s_mov_b32 s31, s30
    s_add_u32 s30, s30, 0x8000
    s_cmp_eq_u32 s30, s32
    s_cselect_b32 s30, s33, s30
    s_cmp_eq_u32 s30, s34
    s_cselect_b32 s30, s35, s30
    ds_read_b64_tr_b16 v[132:133], v169 offset:32768
    ds_read_b64_tr_b16 v[134:135], v169 offset:36864
    v_mfma_f32_32x32x16_bf16 v[16:31], v[108:111], a[172:175], v[16:31]
    ds_read_b64_tr_b16 v[136:137], v170 offset:32768
    ds_read_b64_tr_b16 v[138:139], v170 offset:36864
    v_exp_f32 v187, v187
    v_add_f32 v203, v203, v184
    s_waitcnt lgkmcnt(8)
    v_mfma_f32_32x32x16_bf16 v[16:31], v[112:115], a[176:179], v[16:31]
    buffer_load_dword v220, v219, s[12:15], s66 offen
    ds_read_b64_tr_b16 v[140:141], v171 offset:32768
    ds_read_b64_tr_b16 v[142:143], v171 offset:36864
    v_add_f32 v204, v204, v185
    v_cvt_pk_bf16_f32 v94, v184, v185
    v_mfma_f32_32x32x16_bf16 v[16:31], v[116:119], a[180:183], v[16:31]
    ds_read_b64_tr_b16 v[144:145], v168 offset:33024
    ds_read_b64_tr_b16 v[146:147], v168 offset:37120
    v_add_f32 v203, v203, v186
    v_add_f32 v204, v204, v187
    v_cvt_pk_bf16_f32 v95, v186, v187
    s_waitcnt lgkmcnt(10)
    v_mfma_f32_32x32x16_bf16 v[16:31], v[120:123], a[184:187], v[16:31]
    buffer_load_dword v221, v219, s[8:11], s66 offen
    ds_read_b64_tr_b16 v[148:149], v169 offset:33024
    ds_read_b64_tr_b16 v[150:151], v169 offset:37120
    v_mfma_f32_32x32x16_bf16 v[16:31], v[124:127], a[188:191], v[16:31]
    s_add_u32 s66, s66, 0x8000
    v_add_f32 v203, v203, v204
    v_cmp_nle_f32 vcc, v203, v218
    s_nop 3
    s_cbranch_vccz .Lok_i1
    s_getpc_b64 s[40:41]
    s_branch .Lrare1
.Lok_i1:
    v_add_f32 v200, v200, v203
    s_waitcnt lgkmcnt(8)
    v_mfma_f32_32x32x16_bf16 a[0:15], v[128:131], v[80:83], a[0:15]
    ds_read_b64_tr_b16 v[152:153], v170 offset:33024
    ds_read_b64_tr_b16 v[154:155], v170 offset:37120
    v_mfma_f32_32x32x16_bf16 a[16:31], v[132:135], v[80:83], a[16:31]
    ds_read_b64_tr_b16 v[156:157], v171 offset:33024
    ds_read_b64_tr_b16 v[158:159], v171 offset:37120
    v_fma_f32 v184, v0, s28, v202
    v_fma_f32 v185, v1, s28, v202
    s_waitcnt lgkmcnt(8)
    v_mfma_f32_32x32x16_bf16 a[32:47], v[136:139], v[80:83], a[32:47]
    ds_read_b64_tr_b16 v[128:129], v168 offset:40960
    ds_read_b64_tr_b16 v[130:131], v168 offset:45056
    v_fma_f32 v186, v2, s28, v202
    v_fma_f32 v187, v3, s28, v202
    v_mfma_f32_32x32x16_bf16 a[48:63], v[140:143], v[80:83], a[48:63]
    ds_read_b64_tr_b16 v[132:133], v169 offset:40960
    ds_read_b64_tr_b16 v[134:135], v169 offset:45056
    v_exp_f32 v184, v184
    s_waitcnt lgkmcnt(8)
    v_mfma_f32_32x32x16_bf16 a[64:79], v[144:147], v[80:83], a[64:79]
    ds_read_b64_tr_b16 v[136:137], v170 offset:40960
    ds_read_b64_tr_b16 v[138:139], v170 offset:45056
    v_exp_f32 v185, v185
    v_mfma_f32_32x32x16_bf16 a[80:95], v[148:151], v[80:83], a[80:95]
    ds_read_b64_tr_b16 v[140:141], v171 offset:40960
    ds_read_b64_tr_b16 v[142:143], v171 offset:45056
    v_fma_f32 v188, v4, s28, v202
    v_fma_f32 v189, v5, s28, v202
    s_waitcnt lgkmcnt(8)
    v_mfma_f32_32x32x16_bf16 a[96:111], v[152:155], v[80:83], a[96:111]
    ds_read_b64_tr_b16 v[144:145], v168 offset:41216
    ds_read_b64_tr_b16 v[146:147], v168 offset:45312
    v_exp_f32 v186, v186
    v_mfma_f32_32x32x16_bf16 a[112:127], v[156:159], v[80:83], a[112:127]
    ds_read_b64_tr_b16 v[148:149], v169 offset:41216
    ds_read_b64_tr_b16 v[150:151], v169 offset:45312
    v_exp_f32 v187, v187
    s_waitcnt lgkmcnt(8)
    v_mfma_f32_32x32x16_bf16 a[0:15], v[128:131], v[84:87], a[0:15]
    ds_read_b64_tr_b16 v[152:153], v170 offset:41216
    ds_read_b64_tr_b16 v[154:155], v170 offset:45312
    v_mov_b32 v203, v184
    v_mfma_f32_32x32x16_bf16 a[16:31], v[132:135], v[84:87], a[16:31]
    ds_read_b64_tr_b16 v[156:157], v171 offset:41216
    ds_read_b64_tr_b16 v[158:159], v171 offset:45312
    v_mov_b32 v204, v185
    v_cvt_pk_bf16_f32 v64, v184, v185
    s_waitcnt lgkmcnt(8)
    v_mfma_f32_32x32x16_bf16 a[32:47], v[136:139], v[84:87], a[32:47]
    ds_read_b64_tr_b16 v[128:129], v168 offset:49152
    ds_read_b64_tr_b16 v[130:131], v168 offset:53248
    v_fma_f32 v190, v6, s28, v202
    v_fma_f32 v191, v7, s28, v202
    v_mfma_f32_32x32x16_bf16 a[48:63], v[140:143], v[84:87], a[48:63]
    ds_read_b64_tr_b16 v[132:133], v169 offset:49152
    ds_read_b64_tr_b16 v[134:135], v169 offset:53248
    v_exp_f32 v188, v188
    s_waitcnt lgkmcnt(8)
    v_mfma_f32_32x32x16_bf16 a[64:79], v[144:147], v[84:87], a[64:79]
    ds_read_b64_tr_b16 v[136:137], v170 offset:49152
    ds_read_b64_tr_b16 v[138:139], v170 offset:53248
    v_exp_f32 v189, v189
    v_mfma_f32_32x32x16_bf16 a[80:95], v[148:151], v[84:87], a[80:95]
    ds_read_b64_tr_b16 v[140:141], v171 offset:49152
    ds_read_b64_tr_b16 v[142:143], v171 offset:53248
    v_add_f32 v203, v203, v186
    v_add_f32 v204, v204, v187
    s_waitcnt lgkmcnt(8)
    v_mfma_f32_32x32x16_bf16 a[96:111], v[152:155], v[84:87], a[96:111]
    ds_read_b64_tr_b16 v[144:145], v168 offset:49408
    ds_read_b64_tr_b16 v[146:147], v168 offset:53504
    v_cvt_pk_bf16_f32 v65, v186, v187
    v_fma_f32 v184, v8, s28, v202
    v_mfma_f32_32x32x16_bf16 a[112:127], v[156:159], v[84:87], a[112:127]
    ds_read_b64_tr_b16 v[148:149], v169 offset:49408
    ds_read_b64_tr_b16 v[150:151], v169 offset:53504
    v_fma_f32 v185, v9, s28, v202
    s_waitcnt lgkmcnt(8)
    v_mfma_f32_32x32x16_bf16 a[0:15], v[128:131], v[88:91], a[0:15]
    ds_read_b64_tr_b16 v[152:153], v170 offset:49408
    ds_read_b64_tr_b16 v[154:155], v170 offset:53504
    v_exp_f32 v190, v190
    v_mfma_f32_32x32x16_bf16 a[16:31], v[132:135], v[88:91], a[16:31]
    ds_read_b64_tr_b16 v[156:157], v171 offset:49408
    ds_read_b64_tr_b16 v[158:159], v171 offset:53504
    v_exp_f32 v191, v191
    v_add_f32 v203, v203, v188
    s_waitcnt lgkmcnt(8)
    v_mfma_f32_32x32x16_bf16 a[32:47], v[136:139], v[88:91], a[32:47]
    ds_read_b64_tr_b16 v[128:129], v168 offset:57344
    ds_read_b64_tr_b16 v[130:131], v168 offset:61440
    v_add_f32 v204, v204, v189
    v_cvt_pk_bf16_f32 v66, v188, v189
    v_mfma_f32_32x32x16_bf16 a[48:63], v[140:143], v[88:91], a[48:63]
    ds_read_b64_tr_b16 v[132:133], v169 offset:57344
    ds_read_b64_tr_b16 v[134:135], v169 offset:61440
    v_fma_f32 v186, v10, s28, v202
    s_waitcnt lgkmcnt(8)
    v_mfma_f32_32x32x16_bf16 a[64:79], v[144:147], v[88:91], a[64:79]
    ds_read_b64_tr_b16 v[136:137], v170 offset:57344
    ds_read_b64_tr_b16 v[138:139], v170 offset:61440
    v_fma_f32 v187, v11, s28, v202
    v_exp_f32 v184, v184
    v_mfma_f32_32x32x16_bf16 a[80:95], v[148:151], v[88:91], a[80:95]
    ds_read_b64_tr_b16 v[140:141], v171 offset:57344
    ds_read_b64_tr_b16 v[142:143], v171 offset:61440
    v_exp_f32 v185, v185
    s_waitcnt lgkmcnt(8)
    v_mfma_f32_32x32x16_bf16 a[96:111], v[152:155], v[88:91], a[96:111]
    ds_read_b64_tr_b16 v[144:145], v168 offset:57600
    ds_read_b64_tr_b16 v[146:147], v168 offset:61696
    v_add_f32 v203, v203, v190
    v_mfma_f32_32x32x16_bf16 a[112:127], v[156:159], v[88:91], a[112:127]
    ds_read_b64_tr_b16 v[148:149], v169 offset:57600
    ds_read_b64_tr_b16 v[150:151], v169 offset:61696
    v_add_f32 v204, v204, v191
    v_cvt_pk_bf16_f32 v67, v190, v191
    s_waitcnt lgkmcnt(8)
    v_mfma_f32_32x32x16_bf16 a[0:15], v[128:131], v[92:95], a[0:15]
    ds_read_b64_tr_b16 v[152:153], v170 offset:57600
    ds_read_b64_tr_b16 v[154:155], v170 offset:61696
    v_exp_f32 v186, v186
    v_mfma_f32_32x32x16_bf16 a[16:31], v[132:135], v[92:95], a[16:31]
    ds_read_b64_tr_b16 v[156:157], v171 offset:57600
    ds_read_b64_tr_b16 v[158:159], v171 offset:61696
    v_exp_f32 v187, v187
    s_waitcnt lgkmcnt(8)
    v_mfma_f32_32x32x16_bf16 a[32:47], v[136:139], v[92:95], a[32:47]
    v_add_f32 v203, v203, v184
    v_add_f32 v204, v204, v185
    v_cvt_pk_bf16_f32 v68, v184, v185
    v_mfma_f32_32x32x16_bf16 a[48:63], v[140:143], v[92:95], a[48:63]
    v_add_f32 v203, v203, v186
    v_add_f32 v204, v204, v187
    v_cvt_pk_bf16_f32 v69, v186, v187
    s_waitcnt lgkmcnt(4)
    v_mfma_f32_32x32x16_bf16 a[64:79], v[144:147], v[92:95], a[64:79]
    s_waitcnt vmcnt(2) lgkmcnt(0)
    s_barrier
    ds_read_b128 v[96:99], v160 offset:32768
    ds_read_b128 v[100:103], v161 offset:32768
    s_add_u32 m0, s29, 98304
    v_mfma_f32_32x32x16_bf16 a[80:95], v[148:151], v[92:95], a[80:95]
    ds_read_b128 v[104:107], v162 offset:32768
    ds_read_b128 v[108:111], v163 offset:32768
    buffer_load_dwordx4 v180, s[12:15], s31 offen offset:0 lds
    v_mfma_f32_32x32x16_bf16 a[96:111], v[152:155], v[92:95], a[96:111]
    ds_read_b128 v[112:115], v164 offset:32768
    ds_read_b128 v[116:119], v165 offset:32768
    buffer_load_dwordx4 v181, s[12:15], s31 offen offset:1024 lds
    v_mfma_f32_32x32x16_bf16 a[112:127], v[156:159], v[92:95], a[112:127]
    ds_read_b128 v[120:123], v166 offset:32768
    ds_read_b128 v[124:127], v167 offset:32768
    buffer_load_dwordx4 v180, s[12:15], s31 offen offset:2048 lds
    s_branch .Lloop
.Lt1m_pre:
    s_cmp_eq_u32 s39, 1
    s_cbranch_scc0 .Lt1m_nf
    s_lshl_b32 s57, s59, 2
    s_add_u32 s57, s57, s60
    s_and_b32 s63, s57, 31
    s_lshr_b32 s57, s57, 5
    s_lshl_b32 s57, s57, 2
    s_add_u32 s57, s57, 64
    v_mov_b32 v213, s57
    s_lshl_b32 s58, 1, s63
    v_mov_b32 v217, s58
    buffer_load_dword v227, v213, s[24:27], 0 offen sc0 sc1
.Lt1m_nf:
    s_add_u32 s57, s51, s52
    s_sub_u32 s57, s57, 2
    s_lshl_b32 s57, s57, 6
    v_subrev_u32 v208, s57, v207
    s_waitcnt lgkmcnt(6)
    v_mfma_f32_32x32x16_bf16 v[0:15], v[96:99], a[128:131], 0
    ds_read_b128 v[96:99], v160 offset:256
    buffer_load_dwordx4 v181, s[12:15], s31 offen offset:3072 lds
    v_fma_f32 v184, v44, s28, v202
    v_fma_f32 v185, v45, s28, v202
    v_mfma_f32_32x32x16_bf16 v[0:15], v[100:103], a[132:135], v[0:15]
    ds_read_b128 v[100:103], v161 offset:256
    v_fma_f32 v186, v46, s28, v202
    v_fma_f32 v187, v47, s28, v202
    v_exp_f32 v184, v184
    s_waitcnt lgkmcnt(6)
    v_mfma_f32_32x32x16_bf16 v[0:15], v[104:107], a[136:139], v[0:15]
    ds_read_b128 v[104:107], v162 offset:256
    s_add_u32 m0, s29, 69632
    s_nop 0
    buffer_load_dwordx4 v182, s[12:15], s31 offen offset:0 lds
    v_exp_f32 v185, v185
    v_mfma_f32_32x32x16_bf16 v[0:15], v[108:111], a[140:143], v[0:15]
    ds_read_b128 v[108:111], v163 offset:256
    v_fma_f32 v188, v48, s28, v202
    v_fma_f32 v189, v49, s28, v202
    v_exp_f32 v186, v186
    s_waitcnt lgkmcnt(6)
    v_mfma_f32_32x32x16_bf16 v[0:15], v[112:115], a[144:147], v[0:15]
    ds_read_b128 v[112:115], v164 offset:256
    buffer_load_dwordx4 v183, s[12:15], s31 offen offset:1024 lds
    v_exp_f32 v187, v187
    v_mfma_f32_32x32x16_bf16 v[0:15], v[116:119], a[148:151], v[0:15]
    ds_read_b128 v[116:119], v165 offset:256
    v_add_f32 v203, v203, v184
    v_add_f32 v204, v204, v185
    v_cvt_pk_bf16_f32 v86, v184, v185
    v_fma_f32 v190, v50, s28, v202
    v_fma_f32 v191, v51, s28, v202
    s_waitcnt lgkmcnt(6)
    v_mfma_f32_32x32x16_bf16 v[0:15], v[120:123], a[152:155], v[0:15]
    ds_read_b128 v[120:123], v166 offset:256
    buffer_load_dwordx4 v182, s[12:15], s31 offen offset:2048 lds
    v_exp_f32 v188, v188
    v_mfma_f32_32x32x16_bf16 v[0:15], v[124:127], a[156:159], v[0:15]
    ds_read_b128 v[124:127], v167 offset:256
    v_exp_f32 v189, v189
    v_add_f32 v203, v203, v186
    v_add_f32 v204, v204, v187
    s_waitcnt lgkmcnt(6)
    v_mfma_f32_32x32x16_bf16 v[0:15], v[96:99], a[160:163], v[0:15]
    ds_read_b128 v[96:99], v160 offset:16384
    buffer_load_dwordx4 v183, s[12:15], s31 offen offset:3072 lds
    v_cvt_pk_bf16_f32 v87, v186, v187
    v_fma_f32 v184, v52, s28, v202
    v_fma_f32 v185, v53, s28, v202
    v_mfma_f32_32x32x16_bf16 v[0:15], v[100:103], a[164:167], v[0:15]
    ds_read_b128 v[100:103], v161 offset:16384
    v_exp_f32 v190, v190
    v_exp_f32 v191, v191
    s_waitcnt lgkmcnt(6)
    v_mfma_f32_32x32x16_bf16 v[0:15], v[104:107], a[168:171], v[0:15]
    ds_read_b128 v[104:107], v162 offset:16384
    s_add_u32 m0, s29, 32768
    s_nop 0
    buffer_load_dwordx4 v172, s[8:11], s30 offen offset:0 lds
    v_add_f32 v203, v203, v188
    v_mfma_f32_32x32x16_bf16 v[0:15], v[108:111], a[172:175], v[0:15]
    ds_read_b128 v[108:111], v163 offset:16384
    v_add_f32 v204, v204, v189
    v_cvt_pk_bf16_f32 v88, v188, v189
    v_fma_f32 v186, v54, s28, v202
    v_fma_f32 v187, v55, s28, v202
    s_waitcnt lgkmcnt(6)
    v_mfma_f32_32x32x16_bf16 v[0:15], v[112:115], a[176:179], v[0:15]
    ds_read_b128 v[112:115], v164 offset:16384
    buffer_load_dwordx4 v173, s[8:11], s30 offen offset:1024 lds
    v_exp_f32 v184, v184
    v_mfma_f32_32x32x16_bf16 v[0:15], v[116:119], a[180:183], v[0:15]
    ds_read_b128 v[116:119], v165 offset:16384
    v_exp_f32 v185, v185
    v_add_f32 v203, v203, v190
    v_add_f32 v204, v204, v191
    v_cvt_pk_bf16_f32 v89, v190, v191
    s_waitcnt lgkmcnt(6)
    v_mfma_f32_32x32x16_bf16 v[0:15], v[120:123], a[184:187], v[0:15]
    ds_read_b128 v[120:123], v166 offset:16384
    buffer_load_dwordx4 v174, s[8:11], s30 offen offset:2048 lds
    v_fma_f32 v188, v56, s28, v202
    v_fma_f32 v189, v57, s28, v202
    v_mfma_f32_32x32x16_bf16 v[0:15], v[124:127], a[188:191], v[0:15]
    ds_read_b128 v[124:127], v167 offset:16384
    v_exp_f32 v186, v186
    v_exp_f32 v187, v187
    s_waitcnt lgkmcnt(6)
    v_mfma_f32_32x32x16_bf16 v[16:31], v[96:99], a[128:131], 0
    ds_read_b128 v[96:99], v160 offset:16640
    buffer_load_dwordx4 v175, s[8:11], s30 offen offset:3072 lds
    v_add_f32 v203, v203, v184
    v_add_f32 v204, v204, v185
    v_cvt_pk_bf16_f32 v90, v184, v185
    v_mfma_f32_32x32x16_bf16 v[16:31], v[100:103], a[132:135], v[16:31]
    ds_read_b128 v[100:103], v161 offset:16640
    v_fma_f32 v190, v58, s28, v202
    v_fma_f32 v191, v59, s28, v202
    v_exp_f32 v188, v188
    s_waitcnt lgkmcnt(6)
    v_mfma_f32_32x32x16_bf16 v[16:31], v[104:107], a[136:139], v[16:31]
    ds_read_b128 v[104:107], v162 offset:16640
    s_add_u32 m0, s29, 36864
    s_nop 0
    buffer_load_dwordx4 v176, s[8:11], s30 offen offset:0 lds
    v_exp_f32 v189, v189
    v_mfma_f32_32x32x16_bf16 v[16:31], v[108:111], a[140:143], v[16:31]
    ds_read_b128 v[108:111], v163 offset:16640
    v_add_f32 v203, v203, v186
    v_add_f32 v204, v204, v187
    v_cvt_pk_bf16_f32 v91, v186, v187
    s_waitcnt lgkmcnt(6)
    v_mfma_f32_32x32x16_bf16 v[16:31], v[112:115], a[144:147], v[16:31]
    ds_read_b128 v[112:115], v164 offset:16640
    buffer_load_dwordx4 v177, s[8:11], s30 offen offset:1024 lds
    v_fma_f32 v184, v60, s28, v202
    v_fma_f32 v185, v61, s28, v202
    v_mfma_f32_32x32x16_bf16 v[16:31], v[116:119], a[148:151], v[16:31]
    ds_read_b128 v[116:119], v165 offset:16640
    v_exp_f32 v190, v190
    v_exp_f32 v191, v191
    v_add_f32 v203, v203, v188
    s_waitcnt lgkmcnt(6)
    v_mfma_f32_32x32x16_bf16 v[16:31], v[120:123], a[152:155], v[16:31]
    ds_read_b128 v[120:123], v166 offset:16640
    buffer_load_dwordx4 v178, s[8:11], s30 offen offset:2048 lds
    v_add_f32 v204, v204, v189
    v_cvt_pk_bf16_f32 v92, v188, v189
    v_mfma_f32_32x32x16_bf16 v[16:31], v[124:127], a[156:159], v[16:31]
    ds_read_b128 v[124:127], v167 offset:16640
    v_fma_f32 v186, v62, s28, v202
    v_fma_f32 v187, v63, s28, v202
    v_exp_f32 v184, v184
    s_waitcnt lgkmcnt(6)
    v_mfma_f32_32x32x16_bf16 v[16:31], v[96:99], a[160:163], v[16:31]
    buffer_load_dwordx4 v179, s[8:11], s30 offen offset:3072 lds
    v_exp_f32 v185, v185
    v_add_f32 v203, v203, v190
    v_add_f32 v204, v204, v191
    v_mfma_f32_32x32x16_bf16 v[16:31], v[100:103], a[164:167], v[16:31]
    ds_read_b64_tr_b16 v[128:129], v168 offset:32768
    ds_read_b64_tr_b16 v[130:131], v168 offset:36864
    v_cvt_pk_bf16_f32 v93, v190, v191
    v_exp_f32 v186, v186
    s_waitcnt lgkmcnt(6)
    v_mfma_f32_32x32x16_bf16 v[16:31], v[104:107], a[168:171], v[16:31]
    s_mov_b32 s31, s30
    s_add_u32 s30, s30, 0x8000
    s_cmp_eq_u32 s30, s32
    s_cselect_b32 s30, s33, s30
    s_cmp_eq_u32 s30, s34
    s_cselect_b32 s30, s35, s30
    ds_read_b64_tr_b16 v[132:133], v169 offset:32768
    ds_read_b64_tr_b16 v[134:135], v169 offset:36864
    v_mfma_f32_32x32x16_bf16 v[16:31], v[108:111], a[172:175], v[16:31]
    ds_read_b64_tr_b16 v[136:137], v170 offset:32768
    ds_read_b64_tr_b16 v[138:139], v170 offset:36864
    v_exp_f32 v187, v187
    v_add_f32 v203, v203, v184
    s_waitcnt lgkmcnt(8)
    v_mfma_f32_32x32x16_bf16 v[16:31], v[112:115], a[176:179], v[16:31]
    buffer_load_dword v220, v219, s[12:15], s66 offen
    ds_read_b64_tr_b16 v[140:141], v171 offset:32768
    ds_read_b64_tr_b16 v[142:143], v171 offset:36864
    v_add_f32 v204, v204, v185
    v_cvt_pk_bf16_f32 v94, v184, v185
    v_mfma_f32_32x32x16_bf16 v[16:31], v[116:119], a[180:183], v[16:31]
    ds_read_b64_tr_b16 v[144:145], v168 offset:33024
    ds_read_b64_tr_b16 v[146:147], v168 offset:37120
    v_add_f32 v203, v203, v186
    v_add_f32 v204, v204, v187
    v_cvt_pk_bf16_f32 v95, v186, v187
    s_waitcnt lgkmcnt(10)
    v_mfma_f32_32x32x16_bf16 v[16:31], v[120:123], a[184:187], v[16:31]
    buffer_load_dword v221, v219, s[8:11], s66 offen
    ds_read_b64_tr_b16 v[148:149], v169 offset:33024
    ds_read_b64_tr_b16 v[150:151], v169 offset:37120
    v_mfma_f32_32x32x16_bf16 v[16:31], v[124:127], a[188:191], v[16:31]
    s_add_u32 s66, s66, 0x8000
    v_add_f32 v203, v203, v204
    v_cmp_nle_f32 vcc, v203, v218
    s_nop 3
    s_cbranch_vccz .Lok_i1m
    s_getpc_b64 s[40:41]
    s_branch .Lrare1
.Lok_i1m:
    v_add_f32 v200, v200, v203
    s_waitcnt lgkmcnt(8)
    v_mfma_f32_32x32x16_bf16 a[0:15], v[128:131], v[80:83], a[0:15]
    ds_read_b64_tr_b16 v[152:153], v170 offset:33024
    ds_read_b64_tr_b16 v[154:155], v170 offset:37120
    v_mfma_f32_32x32x16_bf16 a[16:31], v[132:135], v[80:83], a[16:31]
    ds_read_b64_tr_b16 v[156:157], v171 offset:33024
    ds_read_b64_tr_b16 v[158:159], v171 offset:37120
    v_cmp_lt_i32 s[42:43], v208, 0
    v_cmp_lt_i32 s[44:45], v208, 1
    v_cmp_lt_i32 s[46:47], v208, 2
    v_cmp_lt_i32 s[48:49], v208, 3
    s_waitcnt lgkmcnt(8)
    v_mfma_f32_32x32x16_bf16 a[32:47], v[136:139], v[80:83], a[32:47]
    ds_read_b64_tr_b16 v[128:129], v168 offset:40960
    ds_read_b64_tr_b16 v[130:131], v168 offset:45056
    v_cndmask_b32 v0, v0, v209, s[42:43]
    v_cndmask_b32 v1, v1, v209, s[44:45]
    v_cndmask_b32 v2, v2, v209, s[46:47]
    v_cndmask_b32 v3, v3, v209, s[48:49]
    v_mfma_f32_32x32x16_bf16 a[48:63], v[140:143], v[80:83], a[48:63]
    ds_read_b64_tr_b16 v[132:133], v169 offset:40960
    ds_read_b64_tr_b16 v[134:135], v169 offset:45056
    v_cmp_lt_i32 s[42:43], v208, 8
    v_cmp_lt_i32 s[44:45], v208, 9
    v_cmp_lt_i32 s[46:47], v208, 10
    v_cmp_lt_i32 s[48:49], v208, 11
    v_cndmask_b32 v4, v4, v209, s[42:43]
    s_waitcnt lgkmcnt(8)
    v_mfma_f32_32x32x16_bf16 a[64:79], v[144:147], v[80:83], a[64:79]
    ds_read_b64_tr_b16 v[136:137], v170 offset:40960
    ds_read_b64_tr_b16 v[138:139], v170 offset:45056
    v_cndmask_b32 v5, v5, v209, s[44:45]
    v_cndmask_b32 v6, v6, v209, s[46:47]
    v_cndmask_b32 v7, v7, v209, s[48:49]
    v_cmp_lt_i32 s[42:43], v208, 16
    v_mfma_f32_32x32x16_bf16 a[80:95], v[148:151], v[80:83], a[80:95]
    ds_read_b64_tr_b16 v[140:141], v171 offset:40960
    ds_read_b64_tr_b16 v[142:143], v171 offset:45056
    v_cmp_lt_i32 s[44:45], v208, 17
    v_cmp_lt_i32 s[46:47], v208, 18
    v_cmp_lt_i32 s[48:49], v208, 19
    v_cndmask_b32 v8, v8, v209, s[42:43]
    s_waitcnt lgkmcnt(8)
    v_mfma_f32_32x32x16_bf16 a[96:111], v[152:155], v[80:83], a[96:111]
    ds_read_b64_tr_b16 v[144:145], v168 offset:41216
    ds_read_b64_tr_b16 v[146:147], v168 offset:45312
    v_cndmask_b32 v9, v9, v209, s[44:45]
    v_cndmask_b32 v10, v10, v209, s[46:47]
    v_cndmask_b32 v11, v11, v209, s[48:49]
    v_cmp_lt_i32 s[42:43], v208, 24
    v_mfma_f32_32x32x16_bf16 a[112:127], v[156:159], v[80:83], a[112:127]
    ds_read_b64_tr_b16 v[148:149], v169 offset:41216
    ds_read_b64_tr_b16 v[150:151], v169 offset:45312
    v_cmp_lt_i32 s[44:45], v208, 25
    v_cmp_lt_i32 s[46:47], v208, 26
    v_cmp_lt_i32 s[48:49], v208, 27
    v_cndmask_b32 v12, v12, v209, s[42:43]
    s_waitcnt lgkmcnt(8)
    v_mfma_f32_32x32x16_bf16 a[0:15], v[128:131], v[84:87], a[0:15]
    ds_read_b64_tr_b16 v[152:153], v170 offset:41216
    ds_read_b64_tr_b16 v[154:155], v170 offset:45312
    v_cndmask_b32 v13, v13, v209, s[44:45]
    v_cndmask_b32 v14, v14, v209, s[46:47]
    v_cndmask_b32 v15, v15, v209, s[48:49]
    v_fma_f32 v184, v0, s28, v202
    v_fma_f32 v185, v1, s28, v202
    v_mfma_f32_32x32x16_bf16 a[16:31], v[132:135], v[84:87], a[16:31]
    ds_read_b64_tr_b16 v[156:157], v171 offset:41216
    ds_read_b64_tr_b16 v[158:159], v171 offset:45312
    v_fma_f32 v186, v2, s28, v202
    v_fma_f32 v187, v3, s28, v202
    v_exp_f32 v184, v184
    s_waitcnt lgkmcnt(8)
    v_mfma_f32_32x32x16_bf16 a[32:47], v[136:139], v[84:87], a[32:47]
    ds_read_b64_tr_b16 v[128:129], v168 offset:49152
    ds_read_b64_tr_b16 v[130:131], v168 offset:53248
    v_exp_f32 v185, v185
    v_fma_f32 v188, v4, s28, v202
    v_fma_f32 v189, v5, s28, v202
    v_mfma_f32_32x32x16_bf16 a[48:63], v[140:143], v[84:87], a[48:63]
    ds_read_b64_tr_b16 v[132:133], v169 offset:49152
    ds_read_b64_tr_b16 v[134:135], v169 offset:53248
    v_exp_f32 v186, v186
    v_exp_f32 v187, v187
    s_waitcnt lgkmcnt(8)
    v_mfma_f32_32x32x16_bf16 a[64:79], v[144:147], v[84:87], a[64:79]
    ds_read_b64_tr_b16 v[136:137], v170 offset:49152
    ds_read_b64_tr_b16 v[138:139], v170 offset:53248
    v_mov_b32 v203, v184
    v_mov_b32 v204, v185
    v_cvt_pk_bf16_f32 v64, v184, v185
    v_fma_f32 v190, v6, s28, v202
    v_mfma_f32_32x32x16_bf16 a[80:95], v[148:151], v[84:87], a[80:95]
    ds_read_b64_tr_b16 v[140:141], v171 offset:49152
    ds_read_b64_tr_b16 v[142:143], v171 offset:53248
    v_fma_f32 v191, v7, s28, v202
    v_exp_f32 v188, v188
    v_exp_f32 v189, v189
    s_waitcnt lgkmcnt(8)
    v_mfma_f32_32x32x16_bf16 a[96:111], v[152:155], v[84:87], a[96:111]
    ds_read_b64_tr_b16 v[144:145], v168 offset:49408
    ds_read_b64_tr_b16 v[146:147], v168 offset:53504
    v_add_f32 v203, v203, v186
    v_add_f32 v204, v204, v187
    v_cvt_pk_bf16_f32 v65, v186, v187
    v_fma_f32 v184, v8, s28, v202
    v_mfma_f32_32x32x16_bf16 a[112:127], v[156:159], v[84:87], a[112:127]
    ds_read_b64_tr_b16 v[148:149], v169 offset:49408
    ds_read_b64_tr_b16 v[150:151], v169 offset:53504
    v_fma_f32 v185, v9, s28, v202
    v_exp_f32 v190, v190
    s_waitcnt lgkmcnt(8)
    v_mfma_f32_32x32x16_bf16 a[0:15], v[128:131], v[88:91], a[0:15]
    ds_read_b64_tr_b16 v[152:153], v170 offset:49408
    ds_read_b64_tr_b16 v[154:155], v170 offset:53504
    v_exp_f32 v191, v191
    v_add_f32 v203, v203, v188
    v_add_f32 v204, v204, v189
    v_cvt_pk_bf16_f32 v66, v188, v189
    v_mfma_f32_32x32x16_bf16 a[16:31], v[132:135], v[88:91], a[16:31]
    ds_read_b64_tr_b16 v[156:157], v171 offset:49408
    ds_read_b64_tr_b16 v[158:159], v171 offset:53504
    v_fma_f32 v186, v10, s28, v202
    v_fma_f32 v187, v11, s28, v202
    v_exp_f32 v184, v184
    s_waitcnt lgkmcnt(8)
    v_mfma_f32_32x32x16_bf16 a[32:47], v[136:139], v[88:91], a[32:47]
    ds_read_b64_tr_b16 v[128:129], v168 offset:57344
    ds_read_b64_tr_b16 v[130:131], v168 offset:61440
    v_exp_f32 v185, v185
    v_add_f32 v203, v203, v190
    v_add_f32 v204, v204, v191
    v_mfma_f32_32x32x16_bf16 a[48:63], v[140:143], v[88:91], a[48:63]
    ds_read_b64_tr_b16 v[132:133], v169 offset:57344
    ds_read_b64_tr_b16 v[134:135], v169 offset:61440
    v_cvt_pk_bf16_f32 v67, v190, v191
    v_exp_f32 v186, v186
    v_exp_f32 v187, v187
    s_waitcnt lgkmcnt(8)
    v_mfma_f32_32x32x16_bf16 a[64:79], v[144:147], v[88:91], a[64:79]
    ds_read_b64_tr_b16 v[136:137], v170 offset:57344
    ds_read_b64_tr_b16 v[138:139], v170 offset:61440
    v_add_f32 v203, v203, v184
    v_add_f32 v204, v204, v185
    v_cvt_pk_bf16_f32 v68, v184, v185
    v_add_f32 v203, v203, v186
    v_mfma_f32_32x32x16_bf16 a[80:95], v[148:151], v[88:91], a[80:95]
    ds_read_b64_tr_b16 v[140:141], v171 offset:57344
    ds_read_b64_tr_b16 v[142:143], v171 offset:61440
    v_add_f32 v204, v204, v187
    v_cvt_pk_bf16_f32 v69, v186, v187
    v_cmp_lt_i32 s[42:43], v208, 32
    v_cmp_lt_i32 s[44:45], v208, 33
    s_waitcnt lgkmcnt(8)
    v_mfma_f32_32x32x16_bf16 a[96:111], v[152:155], v[88:91], a[96:111]
    ds_read_b64_tr_b16 v[144:145], v168 offset:57600
    ds_read_b64_tr_b16 v[146:147], v168 offset:61696
    v_cmp_lt_i32 s[46:47], v208, 34
    v_cmp_lt_i32 s[48:49], v208, 35
    v_cndmask_b32 v16, v16, v209, s[42:43]
    v_cndmask_b32 v17, v17, v209, s[44:45]
    v_mfma_f32_32x32x16_bf16 a[112:127], v[156:159], v[88:91], a[112:127]
    ds_read_b64_tr_b16 v[148:149], v169 offset:57600
    ds_read_b64_tr_b16 v[150:151], v169 offset:61696
    v_cndmask_b32 v18, v18, v209, s[46:47]
    v_cndmask_b32 v19, v19, v209, s[48:49]
    v_cmp_lt_i32 s[42:43], v208, 40
    v_cmp_lt_i32 s[44:45], v208, 41
    s_waitcnt lgkmcnt(8)
    v_mfma_f32_32x32x16_bf16 a[0:15], v[128:131], v[92:95], a[0:15]
    ds_read_b64_tr_b16 v[152:153], v170 offset:57600
    ds_read_b64_tr_b16 v[154:155], v170 offset:61696
    v_cmp_lt_i32 s[46:47], v208, 42
    v_cmp_lt_i32 s[48:49], v208, 43
    v_cndmask_b32 v20, v20, v209, s[42:43]
    v_cndmask_b32 v21, v21, v209, s[44:45]
    v_cndmask_b32 v22, v22, v209, s[46:47]
    v_mfma_f32_32x32x16_bf16 a[16:31], v[132:135], v[92:95], a[16:31]
    ds_read_b64_tr_b16 v[156:157], v171 offset:57600
    ds_read_b64_tr_b16 v[158:159], v171 offset:61696
    v_cndmask_b32 v23, v23, v209, s[48:49]
    v_cmp_lt_i32 s[42:43], v208, 48
    v_cmp_lt_i32 s[44:45], v208, 49
    v_cmp_lt_i32 s[46:47], v208, 50
    s_waitcnt lgkmcnt(8)
    v_mfma_f32_32x32x16_bf16 a[32:47], v[136:139], v[92:95], a[32:47]
    v_cmp_lt_i32 s[48:49], v208, 51
    v_cndmask_b32 v24, v24, v209, s[42:43]
    v_cndmask_b32 v25, v25, v209, s[44:45]
    v_cndmask_b32 v26, v26, v209, s[46:47]
    v_cndmask_b32 v27, v27, v209, s[48:49]
    v_cmp_lt_i32 s[42:43], v208, 56
    v_mfma_f32_32x32x16_bf16 a[48:63], v[140:143], v[92:95], a[48:63]
    v_cmp_lt_i32 s[44:45], v208, 57
    v_cmp_lt_i32 s[46:47], v208, 58
    v_cmp_lt_i32 s[48:49], v208, 59
    v_cndmask_b32 v28, v28, v209, s[42:43]
    v_cndmask_b32 v29, v29, v209, s[44:45]
    v_cndmask_b32 v30, v30, v209, s[46:47]
    v_cndmask_b32 v31, v31, v209, s[48:49]
    s_waitcnt lgkmcnt(4)
    v_mfma_f32_32x32x16_bf16 a[64:79], v[144:147], v[92:95], a[64:79]
    s_waitcnt vmcnt(2) lgkmcnt(0)
    s_barrier
    ds_read_b128 v[96:99], v160 offset:32768
    ds_read_b128 v[100:103], v161 offset:32768
    s_add_u32 m0, s29, 98304
    v_mfma_f32_32x32x16_bf16 a[80:95], v[148:151], v[92:95], a[80:95]
    ds_read_b128 v[104:107], v162 offset:32768
    ds_read_b128 v[108:111], v163 offset:32768
    buffer_load_dwordx4 v180, s[12:15], s31 offen offset:0 lds
    v_mfma_f32_32x32x16_bf16 a[96:111], v[152:155], v[92:95], a[96:111]
    ds_read_b128 v[112:115], v164 offset:32768
    ds_read_b128 v[116:119], v165 offset:32768
    buffer_load_dwordx4 v181, s[12:15], s31 offen offset:1024 lds
    v_mfma_f32_32x32x16_bf16 a[112:127], v[156:159], v[92:95], a[112:127]
    ds_read_b128 v[120:123], v166 offset:32768
    ds_read_b128 v[124:127], v167 offset:32768
    buffer_load_dwordx4 v180, s[12:15], s31 offen offset:2048 lds
    s_cmp_eq_u32 s39, 1
    s_cbranch_scc0 .Lt0m
    v_readfirstlane_b32 s61, v227
    s_nop 3
    s_lshr_b32 s61, s61, s63
    s_and_b32 s61, s61, 1
    s_cmp_lg_u32 s61, 0
    s_cbranch_scc0 .Lt0m_again
    s_mov_b32 s62, 0
    buffer_load_dwordx4 a[192:195], v215, s[20:23], s62 offen offset:0 sc1
    buffer_load_dwordx4 a[196:199], v215, s[20:23], s62 offen offset:1024 sc1
    buffer_load_dwordx4 a[200:203], v215, s[20:23], s62 offen offset:2048 sc1
    buffer_load_dwordx4 a[204:207], v215, s[20:23], s62 offen offset:3072 sc1
    s_add_u32 s62, s62, 0x1000
    buffer_load_dwordx4 a[208:211], v215, s[20:23], s62 offen offset:0 sc1
    buffer_load_dwordx4 a[212:215], v215, s[20:23], s62 offen offset:1024 sc1
    buffer_load_dwordx4 a[216:219], v215, s[20:23], s62 offen offset:2048 sc1
    buffer_load_dwordx4 a[220:223], v215, s[20:23], s62 offen offset:3072 sc1
    s_add_u32 s62, s62, 0x1000
    buffer_load_dwordx4 a[224:227], v215, s[20:23], s62 offen offset:0 sc1
    buffer_load_dwordx4 a[228:231], v215, s[20:23], s62 offen offset:1024 sc1
    buffer_load_dwordx4 a[232:235], v215, s[20:23], s62 offen offset:2048 sc1
    buffer_load_dwordx4 a[236:239], v215, s[20:23], s62 offen offset:3072 sc1
    s_add_u32 s62, s62, 0x1000
    buffer_load_dwordx4 a[240:243], v215, s[20:23], s62 offen offset:0 sc1
    buffer_load_dwordx4 a[244:247], v215, s[20:23], s62 offen offset:1024 sc1
    buffer_load_dwordx4 a[248:251], v215, s[20:23], s62 offen offset:2048 sc1
    buffer_load_dwordx4 a[252:255], v215, s[20:23], s62 offen offset:3072 sc1
    s_add_u32 s62, s62, 0x1000
    buffer_load_dword v225, v215, s[20:23], s62 offen sc1
    buffer_load_dword v226, v215, s[20:23], s62 offen offset:4 sc1
    s_mov_b32 s70, 1
    s_branch .Lt0m
.Lt0m_again:
    buffer_load_dword v227, v213, s[24:27], 0 offen sc0 sc1
.Lt0m:
    s_cmp_eq_u32 s39, 1
    s_cbranch_scc1 .Lt0m_full
    s_cmp_lt_u32 s60, 2
    s_cbranch_scc1 .Lt0m_lite
.Lt0m_full:
    s_add_u32 s57, s51, s52
    s_sub_u32 s57, s57, 1
    s_lshl_b32 s57, s57, 6
    v_subrev_u32 v208, s57, v207
    s_waitcnt lgkmcnt(6)
    v_mfma_f32_32x32x16_bf16 v[32:47], v[96:99], a[128:131], 0
    ds_read_b128 v[96:99], v160 offset:33024
    buffer_load_dwordx4 v181, s[12:15], s31 offen offset:3072 lds
    v_fma_f32 v184, v12, s28, v202
    v_fma_f32 v185, v13, s28, v202
    v_mfma_f32_32x32x16_bf16 v[32:47], v[100:103], a[132:135], v[32:47]
    ds_read_b128 v[100:103], v161 offset:33024
    v_fma_f32 v186, v14, s28, v202
    v_fma_f32 v187, v15, s28, v202
    v_exp_f32 v184, v184
    s_waitcnt lgkmcnt(6)
    v_mfma_f32_32x32x16_bf16 v[32:47], v[104:107], a[136:139], v[32:47]
    ds_read_b128 v[104:107], v162 offset:33024
    s_add_u32 m0, s29, 102400
    s_nop 0
    buffer_load_dwordx4 v182, s[12:15], s31 offen offset:0 lds
    v_exp_f32 v185, v185
    v_mfma_f32_32x32x16_bf16 v[32:47], v[108:111], a[140:143], v[32:47]
    ds_read_b128 v[108:111], v163 offset:33024
    v_fma_f32 v188, v16, s28, v202
    v_fma_f32 v189, v17, s28, v202
    v_exp_f32 v186, v186
    s_waitcnt lgkmcnt(6)
    v_mfma_f32_32x32x16_bf16 v[32:47], v[112:115], a[144:147], v[32:47]
    ds_read_b128 v[112:115], v164 offset:33024
    buffer_load_dwordx4 v183, s[12:15], s31 offen offset:1024 lds
    v_exp_f32 v187, v187
    v_mfma_f32_32x32x16_bf16 v[32:47], v[116:119], a[148:151], v[32:47]
    ds_read_b128 v[116:119], v165 offset:33024
    v_add_f32 v203, v203, v184
    v_add_f32 v204, v204, v185
    v_cvt_pk_bf16_f32 v70, v184, v185
    v_fma_f32 v190, v18, s28, v202
    v_fma_f32 v191, v19, s28, v202
    s_waitcnt lgkmcnt(6)
    v_mfma_f32_32x32x16_bf16 v[32:47], v[120:123], a[152:155], v[32:47]
    ds_read_b128 v[120:123], v166 offset:33024
    buffer_load_dwordx4 v182, s[12:15], s31 offen offset:2048 lds
    v_exp_f32 v188, v188
    v_mfma_f32_32x32x16_bf16 v[32:47], v[124:127], a[156:159], v[32:47]
    ds_read_b128 v[124:127], v167 offset:33024
    v_exp_f32 v189, v189
    v_add_f32 v203, v203, v186
    v_add_f32 v204, v204, v187
    s_waitcnt lgkmcnt(6)
    v_mfma_f32_32x32x16_bf16 v[32:47], v[96:99], a[160:163], v[32:47]
    ds_read_b128 v[96:99], v160 offset:49152
    buffer_load_dwordx4 v183, s[12:15], s31 offen offset:3072 lds
    v_cvt_pk_bf16_f32 v71, v186, v187
    v_fma_f32 v184, v20, s28, v202
    v_fma_f32 v185, v21, s28, v202
    v_mfma_f32_32x32x16_bf16 v[32:47], v[100:103], a[164:167], v[32:47]
    ds_read_b128 v[100:103], v161 offset:49152
    v_exp_f32 v190, v190
    v_exp_f32 v191, v191
    s_waitcnt lgkmcnt(6)
    v_mfma_f32_32x32x16_bf16 v[32:47], v[104:107], a[168:171], v[32:47]
    ds_read_b128 v[104:107], v162 offset:49152
    s_add_u32 m0, s29, 0
    s_nop 0
    buffer_load_dwordx4 v172, s[8:11], s30 offen offset:0 lds
    v_add_f32 v203, v203, v188
    v_mfma_f32_32x32x16_bf16 v[32:47], v[108:111], a[172:175], v[32:47]
    ds_read_b128 v[108:111], v163 offset:49152
    v_add_f32 v204, v204, v189
    v_cvt_pk_bf16_f32 v72, v188, v189
    v_fma_f32 v186, v22, s28, v202
    v_fma_f32 v187, v23, s28, v202
    s_waitcnt lgkmcnt(6)
    v_mfma_f32_32x32x16_bf16 v[32:47], v[112:115], a[176:179], v[32:47]
    ds_read_b128 v[112:115], v164 offset:49152
    buffer_load_dwordx4 v173, s[8:11], s30 offen offset:1024 lds
    v_exp_f32 v184, v184
    v_mfma_f32_32x32x16_bf16 v[32:47], v[116:119], a[180:183], v[32:47]
    ds_read_b128 v[116:119], v165 offset:49152
    v_exp_f32 v185, v185
    v_add_f32 v203, v203, v190
    v_add_f32 v204, v204, v191
    v_cvt_pk_bf16_f32 v73, v190, v191
    s_waitcnt lgkmcnt(6)
    v_mfma_f32_32x32x16_bf16 v[32:47], v[120:123], a[184:187], v[32:47]
    ds_read_b128 v[120:123], v166 offset:49152
    buffer_load_dwordx4 v174, s[8:11], s30 offen offset:2048 lds
    v_fma_f32 v188, v24, s28, v202
    v_fma_f32 v189, v25, s28, v202
    v_mfma_f32_32x32x16_bf16 v[32:47], v[124:127], a[188:191], v[32:47]
    ds_read_b128 v[124:127], v167 offset:49152
    v_exp_f32 v186, v186
    v_exp_f32 v187, v187
    s_waitcnt lgkmcnt(6)
    v_mfma_f32_32x32x16_bf16 v[48:63], v[96:99], a[128:131], 0
    ds_read_b128 v[96:99], v160 offset:49408
    buffer_load_dwordx4 v175, s[8:11], s30 offen offset:3072 lds
    v_add_f32 v203, v203, v184
    v_add_f32 v204, v204, v185
    v_cvt_pk_bf16_f32 v74, v184, v185
    v_mfma_f32_32x32x16_bf16 v[48:63], v[100:103], a[132:135], v[48:63]
    ds_read_b128 v[100:103], v161 offset:49408
    v_fma_f32 v190, v26, s28, v202
    v_fma_f32 v191, v27, s28, v202
    v_exp_f32 v188, v188
    s_waitcnt lgkmcnt(6)
    v_mfma_f32_32x32x16_bf16 v[48:63], v[104:107], a[136:139], v[48:63]
    ds_read_b128 v[104:107], v162 offset:49408
    s_add_u32 m0, s29, 4096
    s_nop 0
    buffer_load_dwordx4 v176, s[8:11], s30 offen offset:0 lds
    v_exp_f32 v189, v189
    v_mfma_f32_32x32x16_bf16 v[48:63], v[108:111], a[140:143], v[48:63]
    ds_read_b128 v[108:111], v163 offset:49408
    v_add_f32 v203, v203, v186
    v_add_f32 v204, v204, v187
    v_cvt_pk_bf16_f32 v75, v186, v187
    s_waitcnt lgkmcnt(6)
    v_mfma_f32_32x32x16_bf16 v[48:63], v[112:115], a[144:147], v[48:63]
    ds_read_b128 v[112:115], v164 offset:49408
    buffer_load_dwordx4 v177, s[8:11], s30 offen offset:1024 lds
    v_fma_f32 v184, v28, s28, v202
    v_fma_f32 v185, v29, s28, v202
    v_mfma_f32_32x32x16_bf16 v[48:63], v[116:119], a[148:151], v[48:63]
    ds_read_b128 v[116:119], v165 offset:49408
    v_exp_f32 v190, v190
    v_exp_f32 v191, v191
    v_add_f32 v203, v203, v188
    s_waitcnt lgkmcnt(6)
    v_mfma_f32_32x32x16_bf16 v[48:63], v[120:123], a[152:155], v[48:63]
    ds_read_b128 v[120:123], v166 offset:49408
    buffer_load_dwordx4 v178, s[8:11], s30 offen offset:2048 lds
    v_add_f32 v204, v204, v189
    v_cvt_pk_bf16_f32 v76, v188, v189
    v_mfma_f32_32x32x16_bf16 v[48:63], v[124:127], a[156:159], v[48:63]
    ds_read_b128 v[124:127], v167 offset:49408
    v_fma_f32 v186, v30, s28, v202
    v_fma_f32 v187, v31, s28, v202
    v_exp_f32 v184, v184
    s_waitcnt lgkmcnt(6)
    v_mfma_f32_32x32x16_bf16 v[48:63], v[96:99], a[160:163], v[48:63]
    buffer_load_dwordx4 v179, s[8:11], s30 offen offset:3072 lds
    v_exp_f32 v185, v185
    v_add_f32 v203, v203, v190
    v_add_f32 v204, v204, v191
    v_mfma_f32_32x32x16_bf16 v[48:63], v[100:103], a[164:167], v[48:63]
    ds_read_b64_tr_b16 v[128:129], v168 offset:0
    ds_read_b64_tr_b16 v[130:131], v168 offset:4096
    v_cvt_pk_bf16_f32 v77, v190, v191
    v_exp_f32 v186, v186
    s_waitcnt lgkmcnt(6)
    v_mfma_f32_32x32x16_bf16 v[48:63], v[104:107], a[168:171], v[48:63]
    s_mov_b32 s31, s30
    s_add_u32 s30, s30, 0x8000
    s_cmp_eq_u32 s30, s32
    s_cselect_b32 s30, s33, s30
    s_cmp_eq_u32 s30, s34
    s_cselect_b32 s30, s35, s30
    ds_read_b64_tr_b16 v[132:133], v169 offset:0
    ds_read_b64_tr_b16 v[134:135], v169 offset:4096
    v_mfma_f32_32x32x16_bf16 v[48:63], v[108:111], a[172:175], v[48:63]
    ds_read_b64_tr_b16 v[136:137], v170 offset:0
    ds_read_b64_tr_b16 v[138:139], v170 offset:4096
    v_exp_f32 v187, v187
    v_add_f32 v203, v203, v184
    s_waitcnt lgkmcnt(8)
    v_mfma_f32_32x32x16_bf16 v[48:63], v[112:115], a[176:179], v[48:63]
    buffer_load_dword v220, v219, s[12:15], s66 offen
    ds_read_b64_tr_b16 v[140:141], v171 offset:0
    ds_read_b64_tr_b16 v[142:143], v171 offset:4096
    v_add_f32 v204, v204, v185
    v_cvt_pk_bf16_f32 v78, v184, v185
    v_mfma_f32_32x32x16_bf16 v[48:63], v[116:119], a[180:183], v[48:63]
    ds_read_b64_tr_b16 v[144:145], v168 offset:256
    ds_read_b64_tr_b16 v[146:147], v168 offset:4352
    v_add_f32 v203, v203, v186
    v_add_f32 v204, v204, v187
    v_cvt_pk_bf16_f32 v79, v186, v187
    s_waitcnt lgkmcnt(10)
    v_mfma_f32_32x32x16_bf16 v[48:63], v[120:123], a[184:187], v[48:63]
    buffer_load_dword v221, v219, s[8:11], s66 offen
    ds_read_b64_tr_b16 v[148:149], v169 offset:256
    ds_read_b64_tr_b16 v[150:151], v169 offset:4352
    v_mfma_f32_32x32x16_bf16 v[48:63], v[124:127], a[188:191], v[48:63]
    s_add_u32 s66, s66, 0x8000
    v_add_f32 v203, v203, v204
    v_cmp_nle_f32 vcc, v203, v218
    s_nop 3
    s_cbranch_vccz .Lok_i0m
    s_getpc_b64 s[40:41]
    s_branch .Lrare0
.Lok_i0m:
    v_add_f32 v200, v200, v203
    s_waitcnt lgkmcnt(8)
    v_mfma_f32_32x32x16_bf16 a[0:15], v[128:131], v[64:67], a[0:15]
    ds_read_b64_tr_b16 v[152:153], v170 offset:256
    ds_read_b64_tr_b16 v[154:155], v170 offset:4352
    v_mfma_f32_32x32x16_bf16 a[16:31], v[132:135], v[64:67], a[16:31]
    ds_read_b64_tr_b16 v[156:157], v171 offset:256
    ds_read_b64_tr_b16 v[158:159], v171 offset:4352
    v_cmp_lt_i32 s[42:43], v208, 0
    v_cmp_lt_i32 s[44:45], v208, 1
    v_cmp_lt_i32 s[46:47], v208, 2
    v_cmp_lt_i32 s[48:49], v208, 3
    s_waitcnt lgkmcnt(8)
    v_mfma_f32_32x32x16_bf16 a[32:47], v[136:139], v[64:67], a[32:47]
    ds_read_b64_tr_b16 v[128:129], v168 offset:8192
    ds_read_b64_tr_b16 v[130:131], v168 offset:12288
    v_cndmask_b32 v32, v32, v209, s[42:43]
    v_cndmask_b32 v33, v33, v209, s[44:45]
    v_cndmask_b32 v34, v34, v209, s[46:47]
    v_cndmask_b32 v35, v35, v209, s[48:49]
    v_mfma_f32_32x32x16_bf16 a[48:63], v[140:143], v[64:67], a[48:63]
    ds_read_b64_tr_b16 v[132:133], v169 offset:8192
    ds_read_b64_tr_b16 v[134:135], v169 offset:12288
    v_cmp_lt_i32 s[42:43], v208, 8
    v_cmp_lt_i32 s[44:45], v208, 9
    v_cmp_lt_i32 s[46:47], v208, 10
    v_cmp_lt_i32 s[48:49], v208, 11
    v_cndmask_b32 v36, v36, v209, s[42:43]
    s_waitcnt lgkmcnt(8)
    v_mfma_f32_32x32x16_bf16 a[64:79], v[144:147], v[64:67], a[64:79]
    ds_read_b64_tr_b16 v[136:137], v170 offset:8192
    ds_read_b64_tr_b16 v[138:139], v170 offset:12288
    v_cndmask_b32 v37, v37, v209, s[44:45]
    v_cndmask_b32 v38, v38, v209, s[46:47]
    v_cndmask_b32 v39, v39, v209, s[48:49]
    v_cmp_lt_i32 s[42:43], v208, 16
    v_mfma_f32_32x32x16_bf16 a[80:95], v[148:151], v[64:67], a[80:95]
    ds_read_b64_tr_b16 v[140:141], v171 offset:8192
    ds_read_b64_tr_b16 v[142:143], v171 offset:12288
    v_cmp_lt_i32 s[44:45], v208, 17
    v_cmp_lt_i32 s[46:47], v208, 18
    v_cmp_lt_i32 s[48:49], v208, 19
    v_cndmask_b32 v40, v40, v209, s[42:43]
    s_waitcnt lgkmcnt(8)
    v_mfma_f32_32x32x16_bf16 a[96:111], v[152:155], v[64:67], a[96:111]
    ds_read_b64_tr_b16 v[144:145], v168 offset:8448
    ds_read_b64_tr_b16 v[146:147], v168 offset:12544
    v_cndmask_b32 v41, v41, v209, s[44:45]
    v_cndmask_b32 v42, v42, v209, s[46:47]
    v_cndmask_b32 v43, v43, v209, s[48:49]
    v_cmp_lt_i32 s[42:43], v208, 24
    v_mfma_f32_32x32x16_bf16 a[112:127], v[156:159], v[64:67], a[112:127]
    ds_read_b64_tr_b16 v[148:149], v169 offset:8448
    ds_read_b64_tr_b16 v[150:151], v169 offset:12544
    v_cmp_lt_i32 s[44:45], v208, 25
    v_cmp_lt_i32 s[46:47], v208, 26
    v_cmp_lt_i32 s[48:49], v208, 27
    v_cndmask_b32 v44, v44, v209, s[42:43]
    s_waitcnt lgkmcnt(8)
    v_mfma_f32_32x32x16_bf16 a[0:15], v[128:131], v[68:71], a[0:15]
    ds_read_b64_tr_b16 v[152:153], v170 offset:8448
    ds_read_b64_tr_b16 v[154:155], v170 offset:12544
    v_cndmask_b32 v45, v45, v209, s[44:45]
    v_cndmask_b32 v46, v46, v209, s[46:47]
    v_cndmask_b32 v47, v47, v209, s[48:49]
    v_fma_f32 v184, v32, s28, v202
    v_fma_f32 v185, v33, s28, v202
    v_mfma_f32_32x32x16_bf16 a[16:31], v[132:135], v[68:71], a[16:31]
    ds_read_b64_tr_b16 v[156:157], v171 offset:8448
    ds_read_b64_tr_b16 v[158:159], v171 offset:12544
    v_fma_f32 v186, v34, s28, v202
    v_fma_f32 v187, v35, s28, v202
    v_exp_f32 v184, v184
    s_waitcnt lgkmcnt(8)
    v_mfma_f32_32x32x16_bf16 a[32:47], v[136:139], v[68:71], a[32:47]
    ds_read_b64_tr_b16 v[128:129], v168 offset:16384
    ds_read_b64_tr_b16 v[130:131], v168 offset:20480
    v_exp_f32 v185, v185
    v_fma_f32 v188, v36, s28, v202
    v_fma_f32 v189, v37, s28, v202
    v_mfma_f32_32x32x16_bf16 a[48:63], v[140:143], v[68:71], a[48:63]
    ds_read_b64_tr_b16 v[132:133], v169 offset:16384
    ds_read_b64_tr_b16 v[134:135], v169 offset:20480
    v_exp_f32 v186, v186
    v_exp_f32 v187, v187
    s_waitcnt lgkmcnt(8)
    v_mfma_f32_32x32x16_bf16 a[64:79], v[144:147], v[68:71], a[64:79]
    ds_read_b64_tr_b16 v[136:137], v170 offset:16384
    ds_read_b64_tr_b16 v[138:139], v170 offset:20480
    v_mov_b32 v203, v184
    v_mov_b32 v204, v185
    v_cvt_pk_bf16_f32 v80, v184, v185
    v_fma_f32 v190, v38, s28, v202
    v_mfma_f32_32x32x16_bf16 a[80:95], v[148:151], v[68:71], a[80:95]
    ds_read_b64_tr_b16 v[140:141], v171 offset:16384
    ds_read_b64_tr_b16 v[142:143], v171 offset:20480
    v_fma_f32 v191, v39, s28, v202
    v_exp_f32 v188, v188
    v_exp_f32 v189, v189
    s_waitcnt lgkmcnt(8)
    v_mfma_f32_32x32x16_bf16 a[96:111], v[152:155], v[68:71], a[96:111]
    ds_read_b64_tr_b16 v[144:145], v168 offset:16640
    ds_read_b64_tr_b16 v[146:147], v168 offset:20736
    v_add_f32 v203, v203, v186
    v_add_f32 v204, v204, v187
    v_cvt_pk_bf16_f32 v81, v186, v187
    v_fma_f32 v184, v40, s28, v202
    v_mfma_f32_32x32x16_bf16 a[112:127], v[156:159], v[68:71], a[112:127]
    ds_read_b64_tr_b16 v[148:149], v169 offset:16640
    ds_read_b64_tr_b16 v[150:151], v169 offset:20736
    v_fma_f32 v185, v41, s28, v202
    v_exp_f32 v190, v190
    s_waitcnt lgkmcnt(8)
    v_mfma_f32_32x32x16_bf16 a[0:15], v[128:131], v[72:75], a[0:15]
    ds_read_b64_tr_b16 v[152:153], v170 offset:16640
    ds_read_b64_tr_b16 v[154:155], v170 offset:20736
    v_exp_f32 v191, v191
    v_add_f32 v203, v203, v188
    v_add_f32 v204, v204, v189
    v_cvt_pk_bf16_f32 v82, v188, v189
    v_mfma_f32_32x32x16_bf16 a[16:31], v[132:135], v[72:75], a[16:31]
    ds_read_b64_tr_b16 v[156:157], v171 offset:16640
    ds_read_b64_tr_b16 v[158:159], v171 offset:20736
    v_fma_f32 v186, v42, s28, v202
    v_fma_f32 v187, v43, s28, v202
    v_exp_f32 v184, v184
    s_waitcnt lgkmcnt(8)
    v_mfma_f32_32x32x16_bf16 a[32:47], v[136:139], v[72:75], a[32:47]
    ds_read_b64_tr_b16 v[128:129], v168 offset:24576
    ds_read_b64_tr_b16 v[130:131], v168 offset:28672
    v_exp_f32 v185, v185
    v_add_f32 v203, v203, v190
    v_add_f32 v204, v204, v191
    v_mfma_f32_32x32x16_bf16 a[48:63], v[140:143], v[72:75], a[48:63]
    ds_read_b64_tr_b16 v[132:133], v169 offset:24576
    ds_read_b64_tr_b16 v[134:135], v169 offset:28672
    v_cvt_pk_bf16_f32 v83, v190, v191
    v_exp_f32 v186, v186
    v_exp_f32 v187, v187
    s_waitcnt lgkmcnt(8)
    v_mfma_f32_32x32x16_bf16 a[64:79], v[144:147], v[72:75], a[64:79]
    ds_read_b64_tr_b16 v[136:137], v170 offset:24576
    ds_read_b64_tr_b16 v[138:139], v170 offset:28672
    v_add_f32 v203, v203, v184
    v_add_f32 v204, v204, v185
    v_cvt_pk_bf16_f32 v84, v184, v185
    v_add_f32 v203, v203, v186
    v_mfma_f32_32x32x16_bf16 a[80:95], v[148:151], v[72:75], a[80:95]
    ds_read_b64_tr_b16 v[140:141], v171 offset:24576
    ds_read_b64_tr_b16 v[142:143], v171 offset:28672
    v_add_f32 v204, v204, v187
    v_cvt_pk_bf16_f32 v85, v186, v187
    v_cmp_lt_i32 s[42:43], v208, 32
    v_cmp_lt_i32 s[44:45], v208, 33
    s_waitcnt lgkmcnt(8)
    v_mfma_f32_32x32x16_bf16 a[96:111], v[152:155], v[72:75], a[96:111]
    ds_read_b64_tr_b16 v[144:145], v168 offset:24832
    ds_read_b64_tr_b16 v[146:147], v168 offset:28928
    v_cmp_lt_i32 s[46:47], v208, 34
    v_cmp_lt_i32 s[48:49], v208, 35
    v_cndmask_b32 v48, v48, v209, s[42:43]
    v_cndmask_b32 v49, v49, v209, s[44:45]
    v_mfma_f32_32x32x16_bf16 a[112:127], v[156:159], v[72:75], a[112:127]
    ds_read_b64_tr_b16 v[148:149], v169 offset:24832
    ds_read_b64_tr_b16 v[150:151], v169 offset:28928
    v_cndmask_b32 v50, v50, v209, s[46:47]
    v_cndmask_b32 v51, v51, v209, s[48:49]
    v_cmp_lt_i32 s[42:43], v208, 40
    v_cmp_lt_i32 s[44:45], v208, 41
    s_waitcnt lgkmcnt(8)
    v_mfma_f32_32x32x16_bf16 a[0:15], v[128:131], v[76:79], a[0:15]
    ds_read_b64_tr_b16 v[152:153], v170 offset:24832
    ds_read_b64_tr_b16 v[154:155], v170 offset:28928
    v_cmp_lt_i32 s[46:47], v208, 42
    v_cmp_lt_i32 s[48:49], v208, 43
    v_cndmask_b32 v52, v52, v209, s[42:43]
    v_cndmask_b32 v53, v53, v209, s[44:45]
    v_cndmask_b32 v54, v54, v209, s[46:47]
    v_mfma_f32_32x32x16_bf16 a[16:31], v[132:135], v[76:79], a[16:31]
    ds_read_b64_tr_b16 v[156:157], v171 offset:24832
    ds_read_b64_tr_b16 v[158:159], v171 offset:28928
    v_cndmask_b32 v55, v55, v209, s[48:49]
    v_cmp_lt_i32 s[42:43], v208, 48
    v_cmp_lt_i32 s[44:45], v208, 49
    v_cmp_lt_i32 s[46:47], v208, 50
    s_waitcnt lgkmcnt(8)
    v_mfma_f32_32x32x16_bf16 a[32:47], v[136:139], v[76:79], a[32:47]
    v_cmp_lt_i32 s[48:49], v208, 51
    v_cndmask_b32 v56, v56, v209, s[42:43]
    v_cndmask_b32 v57, v57, v209, s[44:45]
    v_cndmask_b32 v58, v58, v209, s[46:47]
    v_cndmask_b32 v59, v59, v209, s[48:49]
    v_cmp_lt_i32 s[42:43], v208, 56
    v_mfma_f32_32x32x16_bf16 a[48:63], v[140:143], v[76:79], a[48:63]
    v_cmp_lt_i32 s[44:45], v208, 57
    v_cmp_lt_i32 s[46:47], v208, 58
    v_cmp_lt_i32 s[48:49], v208, 59
    v_cndmask_b32 v60, v60, v209, s[42:43]
    v_cndmask_b32 v61, v61, v209, s[44:45]
    v_cndmask_b32 v62, v62, v209, s[46:47]
    v_cndmask_b32 v63, v63, v209, s[48:49]
    s_waitcnt lgkmcnt(4)
    v_mfma_f32_32x32x16_bf16 a[64:79], v[144:147], v[76:79], a[64:79]
    s_waitcnt vmcnt(2) lgkmcnt(0)
    s_barrier
    ds_read_b128 v[96:99], v160 offset:0
    ds_read_b128 v[100:103], v161 offset:0
    s_add_u32 m0, s29, 65536
    v_mfma_f32_32x32x16_bf16 a[80:95], v[148:151], v[76:79], a[80:95]
    ds_read_b128 v[104:107], v162 offset:0
    ds_read_b128 v[108:111], v163 offset:0
    buffer_load_dwordx4 v180, s[12:15], s31 offen offset:0 lds
    v_mfma_f32_32x32x16_bf16 a[96:111], v[152:155], v[76:79], a[96:111]
    ds_read_b128 v[112:115], v164 offset:0
    ds_read_b128 v[116:119], v165 offset:0
    buffer_load_dwordx4 v181, s[12:15], s31 offen offset:1024 lds
    v_mfma_f32_32x32x16_bf16 a[112:127], v[156:159], v[76:79], a[112:127]
    ds_read_b128 v[120:123], v166 offset:0
    ds_read_b128 v[124:127], v167 offset:0
    buffer_load_dwordx4 v180, s[12:15], s31 offen offset:2048 lds
    s_cmp_eq_u32 s39, 1
    s_cbranch_scc0 .Lf1
    s_cmp_eq_u32 s70, 1
    s_cbranch_scc1 .Lf1
    v_readfirstlane_b32 s61, v227
    s_nop 3
    s_lshr_b32 s61, s61, s63
    s_and_b32 s61, s61, 1
    s_cmp_lg_u32 s61, 0
    s_cbranch_scc0 .Lf1
    s_mov_b32 s62, 0
    buffer_load_dwordx4 a[192:195], v215, s[20:23], s62 offen offset:0 sc1
    buffer_load_dwordx4 a[196:199], v215, s[20:23], s62 offen offset:1024 sc1
    buffer_load_dwordx4 a[200:203], v215, s[20:23], s62 offen offset:2048 sc1
    buffer_load_dwordx4 a[204:207], v215, s[20:23], s62 offen offset:3072 sc1
    s_add_u32 s62, s62, 0x1000
    buffer_load_dwordx4 a[208:211], v215, s[20:23], s62 offen offset:0 sc1
    buffer_load_dwordx4 a[212:215], v215, s[20:23], s62 offen offset:1024 sc1
    buffer_load_dwordx4 a[216:219], v215, s[20:23], s62 offen offset:2048 sc1
    buffer_load_dwordx4 a[220:223], v215, s[20:23], s62 offen offset:3072 sc1
    s_add_u32 s62, s62, 0x1000
    buffer_load_dwordx4 a[224:227], v215, s[20:23], s62 offen offset:0 sc1
    buffer_load_dwordx4 a[228:231], v215, s[20:23], s62 offen offset:1024 sc1
    buffer_load_dwordx4 a[232:235], v215, s[20:23], s62 offen offset:2048 sc1
    buffer_load_dwordx4 a[236:239], v215, s[20:23], s62 offen offset:3072 sc1
    s_add_u32 s62, s62, 0x1000
    buffer_load_dwordx4 a[240:243], v215, s[20:23], s62 offen offset:0 sc1
    buffer_load_dwordx4 a[244:247], v215, s[20:23], s62 offen offset:1024 sc1
    buffer_load_dwordx4 a[248:251], v215, s[20:23], s62 offen offset:2048 sc1
    buffer_load_dwordx4 a[252:255], v215, s[20:23], s62 offen offset:3072 sc1
    s_add_u32 s62, s62, 0x1000
    buffer_load_dword v225, v215, s[20:23], s62 offen sc1
    buffer_load_dword v226, v215, s[20:23], s62 offen offset:4 sc1
    s_mov_b32 s70, 1
.Lf1:
    s_waitcnt lgkmcnt(0)
    buffer_load_dwordx4 v181, s[12:15], s31 offen offset:3072 lds
    v_fma_f32 v184, v44, s28, v202
    v_fma_f32 v185, v45, s28, v202
    v_fma_f32 v186, v46, s28, v202
    v_fma_f32 v187, v47, s28, v202
    v_exp_f32 v184, v184
    s_add_u32 m0, s29, 69632
    s_nop 0
    buffer_load_dwordx4 v182, s[12:15], s31 offen offset:0 lds
    v_exp_f32 v185, v185
    v_fma_f32 v188, v48, s28, v202
    v_fma_f32 v189, v49, s28, v202
    v_exp_f32 v186, v186
    buffer_load_dwordx4 v183, s[12:15], s31 offen offset:1024 lds
    v_exp_f32 v187, v187
    v_add_f32 v203, v203, v184
    v_add_f32 v204, v204, v185
    v_cvt_pk_bf16_f32 v86, v184, v185
    v_fma_f32 v190, v50, s28, v202
    v_fma_f32 v191, v51, s28, v202
    buffer_load_dwordx4 v182, s[12:15], s31 offen offset:2048 lds
    v_exp_f32 v188, v188
    v_exp_f32 v189, v189
    v_add_f32 v203, v203, v186
    v_add_f32 v204, v204, v187
    v_cvt_pk_bf16_f32 v87, v186, v187
    buffer_load_dwordx4 v183, s[12:15], s31 offen offset:3072 lds
    v_fma_f32 v184, v52, s28, v202
    v_fma_f32 v185, v53, s28, v202
    v_exp_f32 v190, v190
    v_exp_f32 v191, v191
    v_add_f32 v203, v203, v188
    s_add_u32 m0, s29, 32768
    s_nop 0
    buffer_load_dwordx4 v172, s[8:11], s30 offen offset:0 lds
    v_add_f32 v204, v204, v189
    v_cvt_pk_bf16_f32 v88, v188, v189
    v_fma_f32 v186, v54, s28, v202
    v_fma_f32 v187, v55, s28, v202
    v_exp_f32 v184, v184
    buffer_load_dwordx4 v173, s[8:11], s30 offen offset:1024 lds
    v_exp_f32 v185, v185
    v_add_f32 v203, v203, v190
    v_add_f32 v204, v204, v191
    v_cvt_pk_bf16_f32 v89, v190, v191
    v_fma_f32 v188, v56, s28, v202
    v_fma_f32 v189, v57, s28, v202
    buffer_load_dwordx4 v174, s[8:11], s30 offen offset:2048 lds
    v_exp_f32 v186, v186
    v_exp_f32 v187, v187
    v_add_f32 v203, v203, v184
    v_add_f32 v204, v204, v185
    buffer_load_dwordx4 v175, s[8:11], s30 offen offset:3072 lds
    v_cvt_pk_bf16_f32 v90, v184, v185
    v_fma_f32 v190, v58, s28, v202
    v_fma_f32 v191, v59, s28, v202
    v_exp_f32 v188, v188
    v_exp_f32 v189, v189
    s_add_u32 m0, s29, 36864
    s_nop 0
    buffer_load_dwordx4 v176, s[8:11], s30 offen offset:0 lds
    v_add_f32 v203, v203, v186
    v_add_f32 v204, v204, v187
    v_cvt_pk_bf16_f32 v91, v186, v187
    v_fma_f32 v184, v60, s28, v202
    v_fma_f32 v185, v61, s28, v202
    buffer_load_dwordx4 v177, s[8:11], s30 offen offset:1024 lds
    v_exp_f32 v190, v190
    v_exp_f32 v191, v191
    v_add_f32 v203, v203, v188
    v_add_f32 v204, v204, v189
    v_cvt_pk_bf16_f32 v92, v188, v189
    v_fma_f32 v186, v62, s28, v202
    buffer_load_dwordx4 v178, s[8:11], s30 offen offset:2048 lds
    v_fma_f32 v187, v63, s28, v202
    v_exp_f32 v184, v184
    v_exp_f32 v185, v185
    v_add_f32 v203, v203, v190
    buffer_load_dwordx4 v179, s[8:11], s30 offen offset:3072 lds
    v_add_f32 v204, v204, v191
    v_cvt_pk_bf16_f32 v93, v190, v191
    v_exp_f32 v186, v186
    ds_read_b64_tr_b16 v[128:129], v168 offset:32768
    ds_read_b64_tr_b16 v[130:131], v168 offset:36864
    v_exp_f32 v187, v187
    s_mov_b32 s31, s30
    s_add_u32 s30, s30, 0x8000
    s_cmp_eq_u32 s30, s32
    s_cselect_b32 s30, s33, s30
    s_cmp_eq_u32 s30, s34
    s_cselect_b32 s30, s35, s30
    ds_read_b64_tr_b16 v[132:133], v169 offset:32768
    ds_read_b64_tr_b16 v[134:135], v169 offset:36864
    ds_read_b64_tr_b16 v[136:137], v170 offset:32768
    ds_read_b64_tr_b16 v[138:139], v170 offset:36864
    v_add_f32 v203, v203, v184
    v_add_f32 v204, v204, v185
    buffer_load_dword v220, v219, s[12:15], s66 offen
    ds_read_b64_tr_b16 v[140:141], v171 offset:32768
    ds_read_b64_tr_b16 v[142:143], v171 offset:36864
    v_cvt_pk_bf16_f32 v94, v184, v185
    ds_read_b64_tr_b16 v[144:145], v168 offset:33024
    ds_read_b64_tr_b16 v[146:147], v168 offset:37120
    v_add_f32 v203, v203, v186
    v_add_f32 v204, v204, v187
    v_cvt_pk_bf16_f32 v95, v186, v187
    buffer_load_dword v221, v219, s[8:11], s66 offen
    ds_read_b64_tr_b16 v[148:149], v169 offset:33024
    ds_read_b64_tr_b16 v[150:151], v169 offset:37120
    s_add_u32 s66, s66, 0x8000
    v_add_f32 v203, v203, v204
    v_cmp_nle_f32 vcc, v203, v218
    s_nop 3
    s_cbranch_vccz .Lok_f1
    s_getpc_b64 s[40:41]
    s_branch .Lrare1
.Lok_f1:
    v_add_f32 v200, v200, v203
    s_waitcnt lgkmcnt(8)
    v_mfma_f32_32x32x16_bf16 a[0:15], v[128:131], v[80:83], a[0:15]
    ds_read_b64_tr_b16 v[152:153], v170 offset:33024
    ds_read_b64_tr_b16 v[154:155], v170 offset:37120
    v_mfma_f32_32x32x16_bf16 a[16:31], v[132:135], v[80:83], a[16:31]
    ds_read_b64_tr_b16 v[156:157], v171 offset:33024
    ds_read_b64_tr_b16 v[158:159], v171 offset:37120
    s_waitcnt lgkmcnt(8)
    v_mfma_f32_32x32x16_bf16 a[32:47], v[136:139], v[80:83], a[32:47]
    ds_read_b64_tr_b16 v[128:129], v168 offset:40960
    ds_read_b64_tr_b16 v[130:131], v168 offset:45056
    v_mfma_f32_32x32x16_bf16 a[48:63], v[140:143], v[80:83], a[48:63]
    ds_read_b64_tr_b16 v[132:133], v169 offset:40960
    ds_read_b64_tr_b16 v[134:135], v169 offset:45056
    s_waitcnt lgkmcnt(8)
    v_mfma_f32_32x32x16_bf16 a[64:79], v[144:147], v[80:83], a[64:79]
    ds_read_b64_tr_b16 v[136:137], v170 offset:40960
    ds_read_b64_tr_b16 v[138:139], v170 offset:45056
    v_mfma_f32_32x32x16_bf16 a[80:95], v[148:151], v[80:83], a[80:95]
    ds_read_b64_tr_b16 v[140:141], v171 offset:40960
    ds_read_b64_tr_b16 v[142:143], v171 offset:45056
    s_waitcnt lgkmcnt(8)
    v_mfma_f32_32x32x16_bf16 a[96:111], v[152:155], v[80:83], a[96:111]
    ds_read_b64_tr_b16 v[144:145], v168 offset:41216
    ds_read_b64_tr_b16 v[146:147], v168 offset:45312
    v_mfma_f32_32x32x16_bf16 a[112:127], v[156:159], v[80:83], a[112:127]
    ds_read_b64_tr_b16 v[148:149], v169 offset:41216
    ds_read_b64_tr_b16 v[150:151], v169 offset:45312
    s_waitcnt lgkmcnt(8)
    v_mfma_f32_32x32x16_bf16 a[0:15], v[128:131], v[84:87], a[0:15]
    ds_read_b64_tr_b16 v[152:153], v170 offset:41216
    ds_read_b64_tr_b16 v[154:155], v170 offset:45312
    v_mfma_f32_32x32x16_bf16 a[16:31], v[132:135], v[84:87], a[16:31]
    ds_read_b64_tr_b16 v[156:157], v171 offset:41216
    ds_read_b64_tr_b16 v[158:159], v171 offset:45312
    s_waitcnt lgkmcnt(8)
    v_mfma_f32_32x32x16_bf16 a[32:47], v[136:139], v[84:87], a[32:47]
    ds_read_b64_tr_b16 v[128:129], v168 offset:49152
    ds_read_b64_tr_b16 v[130:131], v168 offset:53248
    v_mfma_f32_32x32x16_bf16 a[48:63], v[140:143], v[84:87], a[48:63]
    ds_read_b64_tr_b16 v[132:133], v169 offset:49152
    ds_read_b64_tr_b16 v[134:135], v169 offset:53248
    s_waitcnt lgkmcnt(8)
    v_mfma_f32_32x32x16_bf16 a[64:79], v[144:147], v[84:87], a[64:79]
    ds_read_b64_tr_b16 v[136:137], v170 offset:49152
    ds_read_b64_tr_b16 v[138:139], v170 offset:53248
    v_mfma_f32_32x32x16_bf16 a[80:95], v[148:151], v[84:87], a[80:95]
    ds_read_b64_tr_b16 v[140:141], v171 offset:49152
    ds_read_b64_tr_b16 v[142:143], v171 offset:53248
    s_waitcnt lgkmcnt(8)
    v_mfma_f32_32x32x16_bf16 a[96:111], v[152:155], v[84:87], a[96:111]
    ds_read_b64_tr_b16 v[144:145], v168 offset:49408
    ds_read_b64_tr_b16 v[146:147], v168 offset:53504
    v_mfma_f32_32x32x16_bf16 a[112:127], v[156:159], v[84:87], a[112:127]
    ds_read_b64_tr_b16 v[148:149], v169 offset:49408
    ds_read_b64_tr_b16 v[150:151], v169 offset:53504
    s_waitcnt lgkmcnt(8)
    v_mfma_f32_32x32x16_bf16 a[0:15], v[128:131], v[88:91], a[0:15]
    ds_read_b64_tr_b16 v[152:153], v170 offset:49408
    ds_read_b64_tr_b16 v[154:155], v170 offset:53504
    v_mfma_f32_32x32x16_bf16 a[16:31], v[132:135], v[88:91], a[16:31]
    ds_read_b64_tr_b16 v[156:157], v171 offset:49408
    ds_read_b64_tr_b16 v[158:159], v171 offset:53504
    s_waitcnt lgkmcnt(8)
    v_mfma_f32_32x32x16_bf16 a[32:47], v[136:139], v[88:91], a[32:47]
    ds_read_b64_tr_b16 v[128:129], v168 offset:57344
    ds_read_b64_tr_b16 v[130:131], v168 offset:61440
    v_mfma_f32_32x32x16_bf16 a[48:63], v[140:143], v[88:91], a[48:63]
    ds_read_b64_tr_b16 v[132:133], v169 offset:57344
    ds_read_b64_tr_b16 v[134:135], v169 offset:61440
    s_waitcnt lgkmcnt(8)
    v_mfma_f32_32x32x16_bf16 a[64:79], v[144:147], v[88:91], a[64:79]
    ds_read_b64_tr_b16 v[136:137], v170 offset:57344
    ds_read_b64_tr_b16 v[138:139], v170 offset:61440
    v_mfma_f32_32x32x16_bf16 a[80:95], v[148:151], v[88:91], a[80:95]
    ds_read_b64_tr_b16 v[140:141], v171 offset:57344
    ds_read_b64_tr_b16 v[142:143], v171 offset:61440
    s_waitcnt lgkmcnt(8)
    v_mfma_f32_32x32x16_bf16 a[96:111], v[152:155], v[88:91], a[96:111]
    ds_read_b64_tr_b16 v[144:145], v168 offset:57600
    ds_read_b64_tr_b16 v[146:147], v168 offset:61696
    v_mfma_f32_32x32x16_bf16 a[112:127], v[156:159], v[88:91], a[112:127]
    ds_read_b64_tr_b16 v[148:149], v169 offset:57600
    ds_read_b64_tr_b16 v[150:151], v169 offset:61696
    s_waitcnt lgkmcnt(8)
    v_mfma_f32_32x32x16_bf16 a[0:15], v[128:131], v[92:95], a[0:15]
    ds_read_b64_tr_b16 v[152:153], v170 offset:57600
    ds_read_b64_tr_b16 v[154:155], v170 offset:61696
    v_mfma_f32_32x32x16_bf16 a[16:31], v[132:135], v[92:95], a[16:31]
    ds_read_b64_tr_b16 v[156:157], v171 offset:57600
    ds_read_b64_tr_b16 v[158:159], v171 offset:61696
    s_waitcnt lgkmcnt(8)
    v_mfma_f32_32x32x16_bf16 a[32:47], v[136:139], v[92:95], a[32:47]
    v_mfma_f32_32x32x16_bf16 a[48:63], v[140:143], v[92:95], a[48:63]
    s_waitcnt lgkmcnt(4)
    v_mfma_f32_32x32x16_bf16 a[64:79], v[144:147], v[92:95], a[64:79]
    v_mfma_f32_32x32x16_bf16 a[80:95], v[148:151], v[92:95], a[80:95]
    s_waitcnt lgkmcnt(0)
    v_mfma_f32_32x32x16_bf16 a[96:111], v[152:155], v[92:95], a[96:111]
    v_mfma_f32_32x32x16_bf16 a[112:127], v[156:159], v[92:95], a[112:127]
    s_waitcnt lgkmcnt(0)
    s_branch .Lepi
.Lt0m_lite:
    s_waitcnt lgkmcnt(0)
    buffer_load_dwordx4 v181, s[12:15], s31 offen offset:3072 lds
    v_fma_f32 v184, v12, s28, v202
    v_fma_f32 v185, v13, s28, v202
    v_fma_f32 v186, v14, s28, v202
    v_fma_f32 v187, v15, s28, v202
    v_exp_f32 v184, v184
    s_add_u32 m0, s29, 102400
    s_nop 0
    buffer_load_dwordx4 v182, s[12:15], s31 offen offset:0 lds
    v_exp_f32 v185, v185
    v_fma_f32 v188, v16, s28, v202
    v_fma_f32 v189, v17, s28, v202
    v_exp_f32 v186, v186
    buffer_load_dwordx4 v183, s[12:15], s31 offen offset:1024 lds
    v_exp_f32 v187, v187
    v_add_f32 v203, v203, v184
    v_add_f32 v204, v204, v185
    v_cvt_pk_bf16_f32 v70, v184, v185
    v_fma_f32 v190, v18, s28, v202
    v_fma_f32 v191, v19, s28, v202
    buffer_load_dwordx4 v182, s[12:15], s31 offen offset:2048 lds
    v_exp_f32 v188, v188
    v_exp_f32 v189, v189
    v_add_f32 v203, v203, v186
    v_add_f32 v204, v204, v187
    v_cvt_pk_bf16_f32 v71, v186, v187
    buffer_load_dwordx4 v183, s[12:15], s31 offen offset:3072 lds
    v_fma_f32 v184, v20, s28, v202
    v_fma_f32 v185, v21, s28, v202
    v_exp_f32 v190, v190
    v_exp_f32 v191, v191
    v_add_f32 v203, v203, v188
    s_add_u32 m0, s29, 0
    s_nop 0
    buffer_load_dwordx4 v172, s[8:11], s30 offen offset:0 lds
    v_add_f32 v204, v204, v189
    v_cvt_pk_bf16_f32 v72, v188, v189
    v_fma_f32 v186, v22, s28, v202
    v_fma_f32 v187, v23, s28, v202
    v_exp_f32 v184, v184
    buffer_load_dwordx4 v173, s[8:11], s30 offen offset:1024 lds
    v_exp_f32 v185, v185
    v_add_f32 v203, v203, v190
    v_add_f32 v204, v204, v191
    v_cvt_pk_bf16_f32 v73, v190, v191
    v_fma_f32 v188, v24, s28, v202
    v_fma_f32 v189, v25, s28, v202
    buffer_load_dwordx4 v174, s[8:11], s30 offen offset:2048 lds
    v_exp_f32 v186, v186
    v_exp_f32 v187, v187
    v_add_f32 v203, v203, v184
    v_add_f32 v204, v204, v185
    buffer_load_dwordx4 v175, s[8:11], s30 offen offset:3072 lds
    v_cvt_pk_bf16_f32 v74, v184, v185
    v_fma_f32 v190, v26, s28, v202
    v_fma_f32 v191, v27, s28, v202
    v_exp_f32 v188, v188
    v_exp_f32 v189, v189
    s_add_u32 m0, s29, 4096
    s_nop 0
    buffer_load_dwordx4 v176, s[8:11], s30 offen offset:0 lds
    v_add_f32 v203, v203, v186
    v_add_f32 v204, v204, v187
    v_cvt_pk_bf16_f32 v75, v186, v187
    v_fma_f32 v184, v28, s28, v202
    v_fma_f32 v185, v29, s28, v202
    buffer_load_dwordx4 v177, s[8:11], s30 offen offset:1024 lds
    v_exp_f32 v190, v190
    v_exp_f32 v191, v191
    v_add_f32 v203, v203, v188
    v_add_f32 v204, v204, v189
    v_cvt_pk_bf16_f32 v76, v188, v189
    v_fma_f32 v186, v30, s28, v202
    buffer_load_dwordx4 v178, s[8:11], s30 offen offset:2048 lds
    v_fma_f32 v187, v31, s28, v202
    v_exp_f32 v184, v184
    v_exp_f32 v185, v185
    v_add_f32 v203, v203, v190
    buffer_load_dwordx4 v179, s[8:11], s30 offen offset:3072 lds
    v_add_f32 v204, v204, v191
    v_cvt_pk_bf16_f32 v77, v190, v191
    v_exp_f32 v186, v186
    ds_read_b64_tr_b16 v[128:129], v168 offset:0
    ds_read_b64_tr_b16 v[130:131], v168 offset:4096
    v_exp_f32 v187, v187
    s_mov_b32 s31, s30
    s_add_u32 s30, s30, 0x8000
    s_cmp_eq_u32 s30, s32
    s_cselect_b32 s30, s33, s30
    s_cmp_eq_u32 s30, s34
    s_cselect_b32 s30, s35, s30
    ds_read_b64_tr_b16 v[132:133], v169 offset:0
    ds_read_b64_tr_b16 v[134:135], v169 offset:4096
    ds_read_b64_tr_b16 v[136:137], v170 offset:0
    ds_read_b64_tr_b16 v[138:139], v170 offset:4096
    v_add_f32 v203, v203, v184
    v_add_f32 v204, v204, v185
    buffer_load_dword v220, v219, s[12:15], s66 offen
    ds_read_b64_tr_b16 v[140:141], v171 offset:0
    ds_read_b64_tr_b16 v[142:143], v171 offset:4096
    v_cvt_pk_bf16_f32 v78, v184, v185
    ds_read_b64_tr_b16 v[144:145], v168 offset:256
    ds_read_b64_tr_b16 v[146:147], v168 offset:4352
    v_add_f32 v203, v203, v186
    v_add_f32 v204, v204, v187
    v_cvt_pk_bf16_f32 v79, v186, v187
    buffer_load_dword v221, v219, s[8:11], s66 offen
    ds_read_b64_tr_b16 v[148:149], v169 offset:256
    ds_read_b64_tr_b16 v[150:151], v169 offset:4352
    s_add_u32 s66, s66, 0x8000
    v_add_f32 v203, v203, v204
    v_cmp_nle_f32 vcc, v203, v218
    s_nop 3
    s_cbranch_vccz .Lok_l0
    s_getpc_b64 s[40:41]
    s_branch .Lrare0
.Lok_l0:
    v_add_f32 v200, v200, v203
    s_waitcnt lgkmcnt(8)
    v_mfma_f32_32x32x16_bf16 a[0:15], v[128:131], v[64:67], a[0:15]
    ds_read_b64_tr_b16 v[152:153], v170 offset:256
    ds_read_b64_tr_b16 v[154:155], v170 offset:4352
    v_mfma_f32_32x32x16_bf16 a[16:31], v[132:135], v[64:67], a[16:31]
    ds_read_b64_tr_b16 v[156:157], v171 offset:256
    ds_read_b64_tr_b16 v[158:159], v171 offset:4352
    s_waitcnt lgkmcnt(8)
    v_mfma_f32_32x32x16_bf16 a[32:47], v[136:139], v[64:67], a[32:47]
    ds_read_b64_tr_b16 v[128:129], v168 offset:8192
    ds_read_b64_tr_b16 v[130:131], v168 offset:12288
    v_mfma_f32_32x32x16_bf16 a[48:63], v[140:143], v[64:67], a[48:63]
    ds_read_b64_tr_b16 v[132:133], v169 offset:8192
    ds_read_b64_tr_b16 v[134:135], v169 offset:12288
    s_waitcnt lgkmcnt(8)
    v_mfma_f32_32x32x16_bf16 a[64:79], v[144:147], v[64:67], a[64:79]
    ds_read_b64_tr_b16 v[136:137], v170 offset:8192
    ds_read_b64_tr_b16 v[138:139], v170 offset:12288
    v_mfma_f32_32x32x16_bf16 a[80:95], v[148:151], v[64:67], a[80:95]
    ds_read_b64_tr_b16 v[140:141], v171 offset:8192
    ds_read_b64_tr_b16 v[142:143], v171 offset:12288
    s_waitcnt lgkmcnt(8)
    v_mfma_f32_32x32x16_bf16 a[96:111], v[152:155], v[64:67], a[96:111]
    ds_read_b64_tr_b16 v[144:145], v168 offset:8448
    ds_read_b64_tr_b16 v[146:147], v168 offset:12544
    v_mfma_f32_32x32x16_bf16 a[112:127], v[156:159], v[64:67], a[112:127]
    ds_read_b64_tr_b16 v[148:149], v169 offset:8448
    ds_read_b64_tr_b16 v[150:151], v169 offset:12544
    s_waitcnt lgkmcnt(8)
    v_mfma_f32_32x32x16_bf16 a[0:15], v[128:131], v[68:71], a[0:15]
    ds_read_b64_tr_b16 v[152:153], v170 offset:8448
    ds_read_b64_tr_b16 v[154:155], v170 offset:12544
    v_mfma_f32_32x32x16_bf16 a[16:31], v[132:135], v[68:71], a[16:31]
    ds_read_b64_tr_b16 v[156:157], v171 offset:8448
    ds_read_b64_tr_b16 v[158:159], v171 offset:12544
    s_waitcnt lgkmcnt(8)
    v_mfma_f32_32x32x16_bf16 a[32:47], v[136:139], v[68:71], a[32:47]
    ds_read_b64_tr_b16 v[128:129], v168 offset:16384
    ds_read_b64_tr_b16 v[130:131], v168 offset:20480
    v_mfma_f32_32x32x16_bf16 a[48:63], v[140:143], v[68:71], a[48:63]
    ds_read_b64_tr_b16 v[132:133], v169 offset:16384
    ds_read_b64_tr_b16 v[134:135], v169 offset:20480
    s_waitcnt lgkmcnt(8)
    v_mfma_f32_32x32x16_bf16 a[64:79], v[144:147], v[68:71], a[64:79]
    ds_read_b64_tr_b16 v[136:137], v170 offset:16384
    ds_read_b64_tr_b16 v[138:139], v170 offset:20480
    v_mfma_f32_32x32x16_bf16 a[80:95], v[148:151], v[68:71], a[80:95]
    ds_read_b64_tr_b16 v[140:141], v171 offset:16384
    ds_read_b64_tr_b16 v[142:143], v171 offset:20480
    s_waitcnt lgkmcnt(8)
    v_mfma_f32_32x32x16_bf16 a[96:111], v[152:155], v[68:71], a[96:111]
    ds_read_b64_tr_b16 v[144:145], v168 offset:16640
    ds_read_b64_tr_b16 v[146:147], v168 offset:20736
    v_mfma_f32_32x32x16_bf16 a[112:127], v[156:159], v[68:71], a[112:127]
    ds_read_b64_tr_b16 v[148:149], v169 offset:16640
    ds_read_b64_tr_b16 v[150:151], v169 offset:20736
    s_waitcnt lgkmcnt(8)
    v_mfma_f32_32x32x16_bf16 a[0:15], v[128:131], v[72:75], a[0:15]
    ds_read_b64_tr_b16 v[152:153], v170 offset:16640
    ds_read_b64_tr_b16 v[154:155], v170 offset:20736
    v_mfma_f32_32x32x16_bf16 a[16:31], v[132:135], v[72:75], a[16:31]
    ds_read_b64_tr_b16 v[156:157], v171 offset:16640
    ds_read_b64_tr_b16 v[158:159], v171 offset:20736
    s_waitcnt lgkmcnt(8)
    v_mfma_f32_32x32x16_bf16 a[32:47], v[136:139], v[72:75], a[32:47]
    ds_read_b64_tr_b16 v[128:129], v168 offset:24576
    ds_read_b64_tr_b16 v[130:131], v168 offset:28672
    v_mfma_f32_32x32x16_bf16 a[48:63], v[140:143], v[72:75], a[48:63]
    ds_read_b64_tr_b16 v[132:133], v169 offset:24576
    ds_read_b64_tr_b16 v[134:135], v169 offset:28672
    s_waitcnt lgkmcnt(8)
    v_mfma_f32_32x32x16_bf16 a[64:79], v[144:147], v[72:75], a[64:79]
    ds_read_b64_tr_b16 v[136:137], v170 offset:24576
    ds_read_b64_tr_b16 v[138:139], v170 offset:28672
    v_mfma_f32_32x32x16_bf16 a[80:95], v[148:151], v[72:75], a[80:95]
    ds_read_b64_tr_b16 v[140:141], v171 offset:24576
    ds_read_b64_tr_b16 v[142:143], v171 offset:28672
    s_waitcnt lgkmcnt(8)
    v_mfma_f32_32x32x16_bf16 a[96:111], v[152:155], v[72:75], a[96:111]
    ds_read_b64_tr_b16 v[144:145], v168 offset:24832
    ds_read_b64_tr_b16 v[146:147], v168 offset:28928
    v_mfma_f32_32x32x16_bf16 a[112:127], v[156:159], v[72:75], a[112:127]
    ds_read_b64_tr_b16 v[148:149], v169 offset:24832
    ds_read_b64_tr_b16 v[150:151], v169 offset:28928
    s_waitcnt lgkmcnt(8)
    v_mfma_f32_32x32x16_bf16 a[0:15], v[128:131], v[76:79], a[0:15]
    ds_read_b64_tr_b16 v[152:153], v170 offset:24832
    ds_read_b64_tr_b16 v[154:155], v170 offset:28928
    v_mfma_f32_32x32x16_bf16 a[16:31], v[132:135], v[76:79], a[16:31]
    ds_read_b64_tr_b16 v[156:157], v171 offset:24832
    ds_read_b64_tr_b16 v[158:159], v171 offset:28928
    s_waitcnt lgkmcnt(8)
    v_mfma_f32_32x32x16_bf16 a[32:47], v[136:139], v[76:79], a[32:47]
    v_mfma_f32_32x32x16_bf16 a[48:63], v[140:143], v[76:79], a[48:63]
    s_waitcnt lgkmcnt(4)
    v_mfma_f32_32x32x16_bf16 a[64:79], v[144:147], v[76:79], a[64:79]
    s_waitcnt vmcnt(2) lgkmcnt(0)
    s_barrier
    ds_read_b128 v[96:99], v160 offset:0
    ds_read_b128 v[100:103], v161 offset:0
    s_add_u32 m0, s29, 65536
    v_mfma_f32_32x32x16_bf16 a[80:95], v[148:151], v[76:79], a[80:95]
    ds_read_b128 v[104:107], v162 offset:0
    ds_read_b128 v[108:111], v163 offset:0
    buffer_load_dwordx4 v180, s[12:15], s31 offen offset:0 lds
    v_mfma_f32_32x32x16_bf16 a[96:111], v[152:155], v[76:79], a[96:111]
    ds_read_b128 v[112:115], v164 offset:0
    ds_read_b128 v[116:119], v165 offset:0
    buffer_load_dwordx4 v181, s[12:15], s31 offen offset:1024 lds
    v_mfma_f32_32x32x16_bf16 a[112:127], v[156:159], v[76:79], a[112:127]
    ds_read_b128 v[120:123], v166 offset:0
    ds_read_b128 v[124:127], v167 offset:0
    buffer_load_dwordx4 v180, s[12:15], s31 offen offset:2048 lds
    s_waitcnt lgkmcnt(0)
    buffer_load_dwordx4 v181, s[12:15], s31 offen offset:3072 lds
    s_add_u32 m0, s29, 69632
    s_nop 0
    buffer_load_dwordx4 v182, s[12:15], s31 offen offset:0 lds
    buffer_load_dwordx4 v183, s[12:15], s31 offen offset:1024 lds
    buffer_load_dwordx4 v182, s[12:15], s31 offen offset:2048 lds
    buffer_load_dwordx4 v183, s[12:15], s31 offen offset:3072 lds
    s_add_u32 m0, s29, 32768
    s_nop 0
    buffer_load_dwordx4 v172, s[8:11], s30 offen offset:0 lds
    buffer_load_dwordx4 v173, s[8:11], s30 offen offset:1024 lds
    buffer_load_dwordx4 v174, s[8:11], s30 offen offset:2048 lds
    buffer_load_dwordx4 v175, s[8:11], s30 offen offset:3072 lds
    s_add_u32 m0, s29, 36864
    s_nop 0
    buffer_load_dwordx4 v176, s[8:11], s30 offen offset:0 lds
    buffer_load_dwordx4 v177, s[8:11], s30 offen offset:1024 lds
    buffer_load_dwordx4 v178, s[8:11], s30 offen offset:2048 lds
    buffer_load_dwordx4 v179, s[8:11], s30 offen offset:3072 lds
    s_mov_b32 s31, s30
    s_add_u32 s30, s30, 0x8000
    s_cmp_eq_u32 s30, s32
    s_cselect_b32 s30, s33, s30
    s_cmp_eq_u32 s30, s34
    s_cselect_b32 s30, s35, s30
    buffer_load_dword v220, v219, s[12:15], s66 offen
    buffer_load_dword v221, v219, s[8:11], s66 offen
    s_add_u32 s66, s66, 0x8000
    s_nop 7
.Lepi:
    v_mov_b32 v211, v200
    s_nop 1
    v_permlane32_swap_b32 v200, v211
    v_add_f32 v200, v200, v211
    s_cmp_eq_u32 s39, 1
    s_cbranch_scc1 .Lcombine
    s_cmp_ge_u32 s39, 2
    s_cbranch_scc1 .Lpublish
.Lstore:
    v_rcp_f32 v216, v200
    s_nop 7
    s_nop 3
    s_add_u32 s57, s29, 0x20000
    v_and_b32 v211, 31, v210
    v_lshrrev_b32 v212, 5, v210
    v_and_b32 v213, 15, v210
    v_xor_b32 v213, v213, v212
    v_lshl_add_u32 v211, v211, 8, s57
    v_xor_b32 v96, 0, v213
    v_lshl_add_u32 v96, v96, 4, v211
    v_xor_b32 v97, 2, v213
    v_lshl_add_u32 v97, v97, 4, v211
    v_xor_b32 v98, 4, v213
    v_lshl_add_u32 v98, v98, 4, v211
    v_xor_b32 v99, 6, v213
    v_lshl_add_u32 v99, v99, 4, v211
    v_xor_b32 v100, 8, v213
    v_lshl_add_u32 v100, v100, 4, v211
    v_xor_b32 v101, 10, v213
    v_lshl_add_u32 v101, v101, 4, v211
    v_xor_b32 v102, 12, v213
    v_lshl_add_u32 v102, v102, 4, v211
    v_xor_b32 v103, 14, v213
    v_lshl_add_u32 v103, v103, 4, v211
    v_lshrrev_b32 v212, 4, v210
    v_and_b32 v213, 15, v210
    v_add_u32 v104, 0, v212
    v_xor_b32 v217, v104, v213
    v_lshlrev_b32 v217, 4, v217
    v_lshl_add_u32 v104, v104, 8, v217
    v_add_u32 v104, s57, v104
    v_add_u32 v105, 4, v212
    v_xor_b32 v217, v105, v213
    v_lshlrev_b32 v217, 4, v217
    v_lshl_add_u32 v105, v105, 8, v217
    v_add_u32 v105, s57, v105
    v_add_u32 v106, 8, v212
    v_xor_b32 v217, v106, v213
    v_lshlrev_b32 v217, 4, v217
    v_lshl_add_u32 v106, v106, 8, v217
    v_add_u32 v106, s57, v106
    v_add_u32 v107, 12, v212
    v_xor_b32 v217, v107, v213
    v_lshlrev_b32 v217, 4, v217
    v_lshl_add_u32 v107, v107, 8, v217
    v_add_u32 v107, s57, v107
    s_lshl_b32 s58, s60, 14
    v_lshlrev_b32 v108, 9, v212
    v_lshl_add_u32 v108, v213, 4, v108
    v_add_u32 v108, s58, v108
    v_accvgpr_read_b32 v0, a0
    v_accvgpr_read_b32 v1, a1
    v_accvgpr_read_b32 v2, a2
    v_accvgpr_read_b32 v3, a3
    v_accvgpr_read_b32 v4, a4
    v_accvgpr_read_b32 v5, a5
    v_accvgpr_read_b32 v6, a6
    v_accvgpr_read_b32 v7, a7
    v_accvgpr_read_b32 v8, a8
    v_accvgpr_read_b32 v9, a9
    v_accvgpr_read_b32 v10, a10
    v_accvgpr_read_b32 v11, a11
    v_accvgpr_read_b32 v12, a12
    v_accvgpr_read_b32 v13, a13
    v_accvgpr_read_b32 v14, a14
    v_accvgpr_read_b32 v15, a15
    v_mul_f32 v0, v0, v216
    v_mul_f32 v1, v1, v216
    v_mul_f32 v2, v2, v216
    v_mul_f32 v3, v3, v216
    v_mul_f32 v4, v4, v216
    v_mul_f32 v5, v5, v216
    v_mul_f32 v6, v6, v216
    v_mul_f32 v7, v7, v216
    v_mul_f32 v8, v8, v216
    v_mul_f32 v9, v9, v216
    v_mul_f32 v10, v10, v216
    v_mul_f32 v11, v11, v216
    v_mul_f32 v12, v12, v216
    v_mul_f32 v13, v13, v216
    v_mul_f32 v14, v14, v216
    v_mul_f32 v15, v15, v216
    v_cvt_pk_bf16_f32 v16, v0, v1
    v_cvt_pk_bf16_f32 v17, v2, v3
    v_cvt_pk_bf16_f32 v18, v4, v5
    v_cvt_pk_bf16_f32 v19, v6, v7
    v_cvt_pk_bf16_f32 v20, v8, v9
    v_cvt_pk_bf16_f32 v21, v10, v11
    v_cvt_pk_bf16_f32 v22, v12, v13
    v_cvt_pk_bf16_f32 v23, v14, v15
    s_nop 1
    v_permlane32_swap_b32 v16, v18
    v_permlane32_swap_b32 v17, v19
    v_permlane32_swap_b32 v20, v22
    v_permlane32_swap_b32 v21, v23
    ds_write_b128 v96, v[16:19]
    ds_write_b128 v97, v[20:23]
    v_accvgpr_read_b32 v32, a16
    v_accvgpr_read_b32 v33, a17
    v_accvgpr_read_b32 v34, a18
    v_accvgpr_read_b32 v35, a19
    v_accvgpr_read_b32 v36, a20
    v_accvgpr_read_b32 v37, a21
    v_accvgpr_read_b32 v38, a22
    v_accvgpr_read_b32 v39, a23
    v_accvgpr_read_b32 v40, a24
    v_accvgpr_read_b32 v41, a25
    v_accvgpr_read_b32 v42, a26
    v_accvgpr_read_b32 v43, a27
    v_accvgpr_read_b32 v44, a28
    v_accvgpr_read_b32 v45, a29
    v_accvgpr_read_b32 v46, a30
    v_accvgpr_read_b32 v47, a31
    v_mul_f32 v32, v32, v216
    v_mul_f32 v33, v33, v216
    v_mul_f32 v34, v34, v216
    v_mul_f32 v35, v35, v216
    v_mul_f32 v36, v36, v216
    v_mul_f32 v37, v37, v216
    v_mul_f32 v38, v38, v216
    v_mul_f32 v39, v39, v216
    v_mul_f32 v40, v40, v216
    v_mul_f32 v41, v41, v216
    v_mul_f32 v42, v42, v216
    v_mul_f32 v43, v43, v216
    v_mul_f32 v44, v44, v216
    v_mul_f32 v45, v45, v216
    v_mul_f32 v46, v46, v216
    v_mul_f32 v47, v47, v216
    v_cvt_pk_bf16_f32 v48, v32, v33
    v_cvt_pk_bf16_f32 v49, v34, v35
    v_cvt_pk_bf16_f32 v50, v36, v37
    v_cvt_pk_bf16_f32 v51, v38, v39
    v_cvt_pk_bf16_f32 v52, v40, v41
    v_cvt_pk_bf16_f32 v53, v42, v43
    v_cvt_pk_bf16_f32 v54, v44, v45
    v_cvt_pk_bf16_f32 v55, v46, v47
    s_nop 1
    v_permlane32_swap_b32 v48, v50
    v_permlane32_swap_b32 v49, v51
    v_permlane32_swap_b32 v52, v54
    v_permlane32_swap_b32 v53, v55
    ds_write_b128 v98, v[48:51]
    ds_write_b128 v99, v[52:55]
    v_accvgpr_read_b32 v0, a32
    v_accvgpr_read_b32 v1, a33
    v_accvgpr_read_b32 v2, a34
    v_accvgpr_read_b32 v3, a35
    v_accvgpr_read_b32 v4, a36
    v_accvgpr_read_b32 v5, a37
    v_accvgpr_read_b32 v6, a38
    v_accvgpr_read_b32 v7, a39
    v_accvgpr_read_b32 v8, a40
    v_accvgpr_read_b32 v9, a41
    v_accvgpr_read_b32 v10, a42
    v_accvgpr_read_b32 v11, a43
    v_accvgpr_read_b32 v12, a44
    v_accvgpr_read_b32 v13, a45
    v_accvgpr_read_b32 v14, a46
    v_accvgpr_read_b32 v15, a47
    v_mul_f32 v0, v0, v216
    v_mul_f32 v1, v1, v216
    v_mul_f32 v2, v2, v216
    v_mul_f32 v3, v3, v216
    v_mul_f32 v4, v4, v216
    v_mul_f32 v5, v5, v216
    v_mul_f32 v6, v6, v216
    v_mul_f32 v7, v7, v216
    v_mul_f32 v8, v8, v216
    v_mul_f32 v9, v9, v216
    v_mul_f32 v10, v10, v216
    v_mul_f32 v11, v11, v216
    v_mul_f32 v12, v12, v216
    v_mul_f32 v13, v13, v216
    v_mul_f32 v14, v14, v216
    v_mul_f32 v15, v15, v216
    v_cvt_pk_bf16_f32 v16, v0, v1
    v_cvt_pk_bf16_f32 v17, v2, v3
    v_cvt_pk_bf16_f32 v18, v4, v5
    v_cvt_pk_bf16_f32 v19, v6, v7
    v_cvt_pk_bf16_f32 v20, v8, v9
    v_cvt_pk_bf16_f32 v21, v10, v11
    v_cvt_pk_bf16_f32 v22, v12, v13
    v_cvt_pk_bf16_f32 v23, v14, v15
    s_nop 1
    v_permlane32_swap_b32 v16, v18
    v_permlane32_swap_b32 v17, v19
    v_permlane32_swap_b32 v20, v22
    v_permlane32_swap_b32 v21, v23
    ds_write_b128 v100, v[16:19]
    ds_write_b128 v101, v[20:23]
    v_accvgpr_read_b32 v32, a48
    v_accvgpr_read_b32 v33, a49
    v_accvgpr_read_b32 v34, a50
    v_accvgpr_read_b32 v35, a51
    v_accvgpr_read_b32 v36, a52
    v_accvgpr_read_b32 v37, a53
    v_accvgpr_read_b32 v38, a54
    v_accvgpr_read_b32 v39, a55
    v_accvgpr_read_b32 v40, a56
    v_accvgpr_read_b32 v41, a57
    v_accvgpr_read_b32 v42, a58
    v_accvgpr_read_b32 v43, a59
    v_accvgpr_read_b32 v44, a60
    v_accvgpr_read_b32 v45, a61
    v_accvgpr_read_b32 v46, a62
    v_accvgpr_read_b32 v47, a63
    v_mul_f32 v32, v32, v216
    v_mul_f32 v33, v33, v216
    v_mul_f32 v34, v34, v216
    v_mul_f32 v35, v35, v216
    v_mul_f32 v36, v36, v216
    v_mul_f32 v37, v37, v216
    v_mul_f32 v38, v38, v216
    v_mul_f32 v39, v39, v216
    v_mul_f32 v40, v40, v216
    v_mul_f32 v41, v41, v216
    v_mul_f32 v42, v42, v216
    v_mul_f32 v43, v43, v216
    v_mul_f32 v44, v44, v216
    v_mul_f32 v45, v45, v216
    v_mul_f32 v46, v46, v216
    v_mul_f32 v47, v47, v216
    v_cvt_pk_bf16_f32 v48, v32, v33
    v_cvt_pk_bf16_f32 v49, v34, v35
    v_cvt_pk_bf16_f32 v50, v36, v37
    v_cvt_pk_bf16_f32 v51, v38, v39
    v_cvt_pk_bf16_f32 v52, v40, v41
    v_cvt_pk_bf16_f32 v53, v42, v43
    v_cvt_pk_bf16_f32 v54, v44, v45
    v_cvt_pk_bf16_f32 v55, v46, v47
    s_nop 1
    v_permlane32_swap_b32 v48, v50
    v_permlane32_swap_b32 v49, v51
    v_permlane32_swap_b32 v52, v54
    v_permlane32_swap_b32 v53, v55
    ds_write_b128 v102, v[48:51]
    ds_write_b128 v103, v[52:55]
    ds_read_b128 v[112:115], v104 offset:0
    ds_read_b128 v[116:119], v105 offset:0
    ds_read_b128 v[120:123], v106 offset:0
    ds_read_b128 v[124:127], v107 offset:0
    ds_read_b128 v[128:131], v104 offset:4096
    ds_read_b128 v[132:135], v105 offset:4096
    ds_read_b128 v[136:139], v106 offset:4096
    ds_read_b128 v[140:143], v107 offset:4096
    s_mov_b32 s62, s50
    s_waitcnt lgkmcnt(7)
    buffer_store_dwordx4 v[112:115], v108, s[16:19], s62 offen offset:0 sc0 sc1
    s_add_u32 s62, s62, 0x800
    s_waitcnt lgkmcnt(6)
    buffer_store_dwordx4 v[116:119], v108, s[16:19], s62 offen offset:0 sc0 sc1
    s_add_u32 s62, s62, 0x800
    s_waitcnt lgkmcnt(5)
    buffer_store_dwordx4 v[120:123], v108, s[16:19], s62 offen offset:0 sc0 sc1
    s_add_u32 s62, s62, 0x800
    s_waitcnt lgkmcnt(4)
    buffer_store_dwordx4 v[124:127], v108, s[16:19], s62 offen offset:0 sc0 sc1
    s_add_u32 s62, s62, 0x800
    s_waitcnt lgkmcnt(3)
    buffer_store_dwordx4 v[128:131], v108, s[16:19], s62 offen offset:0 sc0 sc1
    s_add_u32 s62, s62, 0x800
    s_waitcnt lgkmcnt(2)
    buffer_store_dwordx4 v[132:135], v108, s[16:19], s62 offen offset:0 sc0 sc1
    s_add_u32 s62, s62, 0x800
    s_waitcnt lgkmcnt(1)
    buffer_store_dwordx4 v[136:139], v108, s[16:19], s62 offen offset:0 sc0 sc1
    s_add_u32 s62, s62, 0x800
    s_waitcnt lgkmcnt(0)
    buffer_store_dwordx4 v[140:143], v108, s[16:19], s62 offen offset:0 sc0 sc1
    v_accvgpr_read_b32 v0, a64
    v_accvgpr_read_b32 v1, a65
    v_accvgpr_read_b32 v2, a66
    v_accvgpr_read_b32 v3, a67
    v_accvgpr_read_b32 v4, a68
    v_accvgpr_read_b32 v5, a69
    v_accvgpr_read_b32 v6, a70
    v_accvgpr_read_b32 v7, a71
    v_accvgpr_read_b32 v8, a72
    v_accvgpr_read_b32 v9, a73
    v_accvgpr_read_b32 v10, a74
    v_accvgpr_read_b32 v11, a75
    v_accvgpr_read_b32 v12, a76
    v_accvgpr_read_b32 v13, a77
    v_accvgpr_read_b32 v14, a78
    v_accvgpr_read_b32 v15, a79
    v_mul_f32 v0, v0, v216
    v_mul_f32 v1, v1, v216
    v_mul_f32 v2, v2, v216
    v_mul_f32 v3, v3, v216
    v_mul_f32 v4, v4, v216
    v_mul_f32 v5, v5, v216
    v_mul_f32 v6, v6, v216
    v_mul_f32 v7, v7, v216
    v_mul_f32 v8, v8, v216
    v_mul_f32 v9, v9, v216
    v_mul_f32 v10, v10, v216
    v_mul_f32 v11, v11, v216
    v_mul_f32 v12, v12, v216
    v_mul_f32 v13, v13, v216
    v_mul_f32 v14, v14, v216
    v_mul_f32 v15, v15, v216
    v_cvt_pk_bf16_f32 v16, v0, v1
    v_cvt_pk_bf16_f32 v17, v2, v3
    v_cvt_pk_bf16_f32 v18, v4, v5
    v_cvt_pk_bf16_f32 v19, v6, v7
    v_cvt_pk_bf16_f32 v20, v8, v9
    v_cvt_pk_bf16_f32 v21, v10, v11
    v_cvt_pk_bf16_f32 v22, v12, v13
    v_cvt_pk_bf16_f32 v23, v14, v15
    s_nop 1
    v_permlane32_swap_b32 v16, v18
    v_permlane32_swap_b32 v17, v19
    v_permlane32_swap_b32 v20, v22
    v_permlane32_swap_b32 v21, v23
    ds_write_b128 v96, v[16:19]
    ds_write_b128 v97, v[20:23]
    v_accvgpr_read_b32 v32, a80
    v_accvgpr_read_b32 v33, a81
    v_accvgpr_read_b32 v34, a82
    v_accvgpr_read_b32 v35, a83
    v_accvgpr_read_b32 v36, a84
    v_accvgpr_read_b32 v37, a85
    v_accvgpr_read_b32 v38, a86
    v_accvgpr_read_b32 v39, a87
    v_accvgpr_read_b32 v40, a88
    v_accvgpr_read_b32 v41, a89
    v_accvgpr_read_b32 v42, a90
    v_accvgpr_read_b32 v43, a91
    v_accvgpr_read_b32 v44, a92
    v_accvgpr_read_b32 v45, a93
    v_accvgpr_read_b32 v46, a94
    v_accvgpr_read_b32 v47, a95
    v_mul_f32 v32, v32, v216
    v_mul_f32 v33, v33, v216
    v_mul_f32 v34, v34, v216
    v_mul_f32 v35, v35, v216
    v_mul_f32 v36, v36, v216
    v_mul_f32 v37, v37, v216
    v_mul_f32 v38, v38, v216
    v_mul_f32 v39, v39, v216
    v_mul_f32 v40, v40, v216
    v_mul_f32 v41, v41, v216
    v_mul_f32 v42, v42, v216
    v_mul_f32 v43, v43, v216
    v_mul_f32 v44, v44, v216
    v_mul_f32 v45, v45, v216
    v_mul_f32 v46, v46, v216
    v_mul_f32 v47, v47, v216
    v_cvt_pk_bf16_f32 v48, v32, v33
    v_cvt_pk_bf16_f32 v49, v34, v35
    v_cvt_pk_bf16_f32 v50, v36, v37
    v_cvt_pk_bf16_f32 v51, v38, v39
    v_cvt_pk_bf16_f32 v52, v40, v41
    v_cvt_pk_bf16_f32 v53, v42, v43
    v_cvt_pk_bf16_f32 v54, v44, v45
    v_cvt_pk_bf16_f32 v55, v46, v47
    s_nop 1
    v_permlane32_swap_b32 v48, v50
    v_permlane32_swap_b32 v49, v51
    v_permlane32_swap_b32 v52, v54
    v_permlane32_swap_b32 v53, v55
    ds_write_b128 v98, v[48:51]
    ds_write_b128 v99, v[52:55]
    v_accvgpr_read_b32 v0, a96
    v_accvgpr_read_b32 v1, a97
    v_accvgpr_read_b32 v2, a98
    v_accvgpr_read_b32 v3, a99
    v_accvgpr_read_b32 v4, a100
    v_accvgpr_read_b32 v5, a101
    v_accvgpr_read_b32 v6, a102
    v_accvgpr_read_b32 v7, a103
    v_accvgpr_read_b32 v8, a104
    v_accvgpr_read_b32 v9, a105
    v_accvgpr_read_b32 v10, a106
    v_accvgpr_read_b32 v11, a107
    v_accvgpr_read_b32 v12, a108
    v_accvgpr_read_b32 v13, a109
    v_accvgpr_read_b32 v14, a110
    v_accvgpr_read_b32 v15, a111
    v_mul_f32 v0, v0, v216
    v_mul_f32 v1, v1, v216
    v_mul_f32 v2, v2, v216
    v_mul_f32 v3, v3, v216
    v_mul_f32 v4, v4, v216
    v_mul_f32 v5, v5, v216
    v_mul_f32 v6, v6, v216
    v_mul_f32 v7, v7, v216
    v_mul_f32 v8, v8, v216
    v_mul_f32 v9, v9, v216
    v_mul_f32 v10, v10, v216
    v_mul_f32 v11, v11, v216
    v_mul_f32 v12, v12, v216
    v_mul_f32 v13, v13, v216
    v_mul_f32 v14, v14, v216
    v_mul_f32 v15, v15, v216
    v_cvt_pk_bf16_f32 v16, v0, v1
    v_cvt_pk_bf16_f32 v17, v2, v3
    v_cvt_pk_bf16_f32 v18, v4, v5
    v_cvt_pk_bf16_f32 v19, v6, v7
    v_cvt_pk_bf16_f32 v20, v8, v9
    v_cvt_pk_bf16_f32 v21, v10, v11
    v_cvt_pk_bf16_f32 v22, v12, v13
    v_cvt_pk_bf16_f32 v23, v14, v15
    s_nop 1
    v_permlane32_swap_b32 v16, v18
    v_permlane32_swap_b32 v17, v19
    v_permlane32_swap_b32 v20, v22
    v_permlane32_swap_b32 v21, v23
    ds_write_b128 v100, v[16:19]
    ds_write_b128 v101, v[20:23]
    v_accvgpr_read_b32 v32, a112
    v_accvgpr_read_b32 v33, a113
    v_accvgpr_read_b32 v34, a114
    v_accvgpr_read_b32 v35, a115
    v_accvgpr_read_b32 v36, a116
    v_accvgpr_read_b32 v37, a117
    v_accvgpr_read_b32 v38, a118
    v_accvgpr_read_b32 v39, a119
    v_accvgpr_read_b32 v40, a120
    v_accvgpr_read_b32 v41, a121
    v_accvgpr_read_b32 v42, a122
    v_accvgpr_read_b32 v43, a123
    v_accvgpr_read_b32 v44, a124
    v_accvgpr_read_b32 v45, a125
    v_accvgpr_read_b32 v46, a126
    v_accvgpr_read_b32 v47, a127
    v_mul_f32 v32, v32, v216
    v_mul_f32 v33, v33, v216
    v_mul_f32 v34, v34, v216
    v_mul_f32 v35, v35, v216
    v_mul_f32 v36, v36, v216
    v_mul_f32 v37, v37, v216
    v_mul_f32 v38, v38, v216
    v_mul_f32 v39, v39, v216
    v_mul_f32 v40, v40, v216
    v_mul_f32 v41, v41, v216
    v_mul_f32 v42, v42, v216
    v_mul_f32 v43, v43, v216
    v_mul_f32 v44, v44, v216
    v_mul_f32 v45, v45, v216
    v_mul_f32 v46, v46, v216
    v_mul_f32 v47, v47, v216
    v_cvt_pk_bf16_f32 v48, v32, v33
    v_cvt_pk_bf16_f32 v49, v34, v35
    v_cvt_pk_bf16_f32 v50, v36, v37
    v_cvt_pk_bf16_f32 v51, v38, v39
    v_cvt_pk_bf16_f32 v52, v40, v41
    v_cvt_pk_bf16_f32 v53, v42, v43
    v_cvt_pk_bf16_f32 v54, v44, v45
    v_cvt_pk_bf16_f32 v55, v46, v47
    s_nop 1
    v_permlane32_swap_b32 v48, v50
    v_permlane32_swap_b32 v49, v51
    v_permlane32_swap_b32 v52, v54
    v_permlane32_swap_b32 v53, v55
    ds_write_b128 v102, v[48:51]
    ds_write_b128 v103, v[52:55]
    ds_read_b128 v[112:115], v104 offset:0
    ds_read_b128 v[116:119], v105 offset:0
    ds_read_b128 v[120:123], v106 offset:0
    ds_read_b128 v[124:127], v107 offset:0
    ds_read_b128 v[128:131], v104 offset:4096
    ds_read_b128 v[132:135], v105 offset:4096
    ds_read_b128 v[136:139], v106 offset:4096
    ds_read_b128 v[140:143], v107 offset:4096
    s_mov_b32 s62, s50
    s_waitcnt lgkmcnt(7)
    buffer_store_dwordx4 v[112:115], v108, s[16:19], s62 offen offset:256 sc0 sc1
    s_add_u32 s62, s62, 0x800
    s_waitcnt lgkmcnt(6)
    buffer_store_dwordx4 v[116:119], v108, s[16:19], s62 offen offset:256 sc0 sc1
    s_add_u32 s62, s62, 0x800
    s_waitcnt lgkmcnt(5)
    buffer_store_dwordx4 v[120:123], v108, s[16:19], s62 offen offset:256 sc0 sc1
    s_add_u32 s62, s62, 0x800
    s_waitcnt lgkmcnt(4)
    buffer_store_dwordx4 v[124:127], v108, s[16:19], s62 offen offset:256 sc0 sc1
    s_add_u32 s62, s62, 0x800
    s_waitcnt lgkmcnt(3)
    buffer_store_dwordx4 v[128:131], v108, s[16:19], s62 offen offset:256 sc0 sc1
    s_add_u32 s62, s62, 0x800
    s_waitcnt lgkmcnt(2)
    buffer_store_dwordx4 v[132:135], v108, s[16:19], s62 offen offset:256 sc0 sc1
    s_add_u32 s62, s62, 0x800
    s_waitcnt lgkmcnt(1)
    buffer_store_dwordx4 v[136:139], v108, s[16:19], s62 offen offset:256 sc0 sc1
    s_add_u32 s62, s62, 0x800
    s_waitcnt lgkmcnt(0)
    buffer_store_dwordx4 v[140:143], v108, s[16:19], s62 offen offset:256 sc0 sc1
    s_cmp_eq_u32 s38, 2
    s_cbranch_scc0 .Lfin
.Lswitch:
    s_mov_b32 s68, 0
    s_mov_b32 s38, 1
    s_mov_b32 s50, s53
    s_mov_b32 s51, s54
    s_mov_b32 s52, s55
    s_mov_b32 s39, s56
    v_accvgpr_mov_b32 a128, a192
    v_accvgpr_mov_b32 a129, a193
    v_accvgpr_mov_b32 a130, a194
    v_accvgpr_mov_b32 a131, a195
    v_accvgpr_mov_b32 a132, a196
    v_accvgpr_mov_b32 a133, a197
    v_accvgpr_mov_b32 a134, a198
    v_accvgpr_mov_b32 a135, a199
    v_accvgpr_mov_b32 a136, a200
    v_accvgpr_mov_b32 a137, a201
    v_accvgpr_mov_b32 a138, a202
    v_accvgpr_mov_b32 a139, a203
    v_accvgpr_mov_b32 a140, a204
    v_accvgpr_mov_b32 a141, a205
    v_accvgpr_mov_b32 a142, a206
    v_accvgpr_mov_b32 a143, a207
    v_accvgpr_mov_b32 a144, a208
    v_accvgpr_mov_b32 a145, a209
    v_accvgpr_mov_b32 a146, a210
    v_accvgpr_mov_b32 a147, a211
    v_accvgpr_mov_b32 a148, a212
    v_accvgpr_mov_b32 a149, a213
    v_accvgpr_mov_b32 a150, a214
    v_accvgpr_mov_b32 a151, a215
    v_accvgpr_mov_b32 a152, a216
    v_accvgpr_mov_b32 a153, a217
    v_accvgpr_mov_b32 a154, a218
    v_accvgpr_mov_b32 a155, a219
    v_accvgpr_mov_b32 a156, a220
    v_accvgpr_mov_b32 a157, a221
    v_accvgpr_mov_b32 a158, a222
    v_accvgpr_mov_b32 a159, a223
    v_accvgpr_mov_b32 a160, a224
    v_accvgpr_mov_b32 a161, a225
    v_accvgpr_mov_b32 a162, a226
    v_accvgpr_mov_b32 a163, a227
    v_accvgpr_mov_b32 a164, a228
    v_accvgpr_mov_b32 a165, a229
    v_accvgpr_mov_b32 a166, a230
    v_accvgpr_mov_b32 a167, a231
    v_accvgpr_mov_b32 a168, a232
    v_accvgpr_mov_b32 a169, a233
    v_accvgpr_mov_b32 a170, a234
    v_accvgpr_mov_b32 a171, a235
    v_accvgpr_mov_b32 a172, a236
    v_accvgpr_mov_b32 a173, a237
    v_accvgpr_mov_b32 a174, a238
    v_accvgpr_mov_b32 a175, a239
    v_accvgpr_mov_b32 a176, a240
    v_accvgpr_mov_b32 a177, a241
    v_accvgpr_mov_b32 a178, a242
    v_accvgpr_mov_b32 a179, a243
    v_accvgpr_mov_b32 a180, a244
    v_accvgpr_mov_b32 a181, a245
    v_accvgpr_mov_b32 a182, a246
    v_accvgpr_mov_b32 a183, a247
    v_accvgpr_mov_b32 a184, a248
    v_accvgpr_mov_b32 a185, a249
    v_accvgpr_mov_b32 a186, a250
    v_accvgpr_mov_b32 a187, a251
    v_accvgpr_mov_b32 a188, a252
    v_accvgpr_mov_b32 a189, a253
    v_accvgpr_mov_b32 a190, a254
    v_accvgpr_mov_b32 a191, a255
    s_branch .Lseg
.Lpublish:
    s_nop 7
    s_nop 3
    s_mov_b32 s62, 0
    v_accvgpr_read_b32 v0, a0
    v_accvgpr_read_b32 v1, a1
    v_accvgpr_read_b32 v2, a2
    v_accvgpr_read_b32 v3, a3
    v_accvgpr_read_b32 v4, a4
    v_accvgpr_read_b32 v5, a5
    v_accvgpr_read_b32 v6, a6
    v_accvgpr_read_b32 v7, a7
    v_accvgpr_read_b32 v8, a8
    v_accvgpr_read_b32 v9, a9
    v_accvgpr_read_b32 v10, a10
    v_accvgpr_read_b32 v11, a11
    v_accvgpr_read_b32 v12, a12
    v_accvgpr_read_b32 v13, a13
    v_accvgpr_read_b32 v14, a14
    v_accvgpr_read_b32 v15, a15
    v_cvt_pk_bf16_f32 v16, v0, v1
    v_cvt_pk_bf16_f32 v17, v2, v3
    v_cvt_pk_bf16_f32 v18, v4, v5
    v_cvt_pk_bf16_f32 v19, v6, v7
    v_cvt_pk_bf16_f32 v20, v8, v9
    v_cvt_pk_bf16_f32 v21, v10, v11
    v_cvt_pk_bf16_f32 v22, v12, v13
    v_cvt_pk_bf16_f32 v23, v14, v15
    buffer_store_dwordx4 v[16:19], v215, s[20:23], s62 offen offset:0 sc1
    buffer_store_dwordx4 v[20:23], v215, s[20:23], s62 offen offset:1024 sc1
    v_accvgpr_read_b32 v32, a16
    v_accvgpr_read_b32 v33, a17
    v_accvgpr_read_b32 v34, a18
    v_accvgpr_read_b32 v35, a19
    v_accvgpr_read_b32 v36, a20
    v_accvgpr_read_b32 v37, a21
    v_accvgpr_read_b32 v38, a22
    v_accvgpr_read_b32 v39, a23
    v_accvgpr_read_b32 v40, a24
    v_accvgpr_read_b32 v41, a25
    v_accvgpr_read_b32 v42, a26
    v_accvgpr_read_b32 v43, a27
    v_accvgpr_read_b32 v44, a28
    v_accvgpr_read_b32 v45, a29
    v_accvgpr_read_b32 v46, a30
    v_accvgpr_read_b32 v47, a31
    v_cvt_pk_bf16_f32 v48, v32, v33
    v_cvt_pk_bf16_f32 v49, v34, v35
    v_cvt_pk_bf16_f32 v50, v36, v37
    v_cvt_pk_bf16_f32 v51, v38, v39
    v_cvt_pk_bf16_f32 v52, v40, v41
    v_cvt_pk_bf16_f32 v53, v42, v43
    v_cvt_pk_bf16_f32 v54, v44, v45
    v_cvt_pk_bf16_f32 v55, v46, v47
    buffer_store_dwordx4 v[48:51], v215, s[20:23], s62 offen offset:2048 sc1
    buffer_store_dwordx4 v[52:55], v215, s[20:23], s62 offen offset:3072 sc1
    s_add_u32 s62, s62, 0x1000
    v_accvgpr_read_b32 v0, a32
    v_accvgpr_read_b32 v1, a33
    v_accvgpr_read_b32 v2, a34
    v_accvgpr_read_b32 v3, a35
    v_accvgpr_read_b32 v4, a36
    v_accvgpr_read_b32 v5, a37
    v_accvgpr_read_b32 v6, a38
    v_accvgpr_read_b32 v7, a39
    v_accvgpr_read_b32 v8, a40
    v_accvgpr_read_b32 v9, a41
    v_accvgpr_read_b32 v10, a42
    v_accvgpr_read_b32 v11, a43
    v_accvgpr_read_b32 v12, a44
    v_accvgpr_read_b32 v13, a45
    v_accvgpr_read_b32 v14, a46
    v_accvgpr_read_b32 v15, a47
    v_cvt_pk_bf16_f32 v16, v0, v1
    v_cvt_pk_bf16_f32 v17, v2, v3
    v_cvt_pk_bf16_f32 v18, v4, v5
    v_cvt_pk_bf16_f32 v19, v6, v7
    v_cvt_pk_bf16_f32 v20, v8, v9
    v_cvt_pk_bf16_f32 v21, v10, v11
    v_cvt_pk_bf16_f32 v22, v12, v13
    v_cvt_pk_bf16_f32 v23, v14, v15
    buffer_store_dwordx4 v[16:19], v215, s[20:23], s62 offen offset:0 sc1
    buffer_store_dwordx4 v[20:23], v215, s[20:23], s62 offen offset:1024 sc1
    v_accvgpr_read_b32 v32, a48
    v_accvgpr_read_b32 v33, a49
    v_accvgpr_read_b32 v34, a50
    v_accvgpr_read_b32 v35, a51
    v_accvgpr_read_b32 v36, a52
    v_accvgpr_read_b32 v37, a53
    v_accvgpr_read_b32 v38, a54
    v_accvgpr_read_b32 v39, a55
    v_accvgpr_read_b32 v40, a56
    v_accvgpr_read_b32 v41, a57
    v_accvgpr_read_b32 v42, a58
    v_accvgpr_read_b32 v43, a59
    v_accvgpr_read_b32 v44, a60
    v_accvgpr_read_b32 v45, a61
    v_accvgpr_read_b32 v46, a62
    v_accvgpr_read_b32 v47, a63
    v_cvt_pk_bf16_f32 v48, v32, v33
    v_cvt_pk_bf16_f32 v49, v34, v35
    v_cvt_pk_bf16_f32 v50, v36, v37
    v_cvt_pk_bf16_f32 v51, v38, v39
    v_cvt_pk_bf16_f32 v52, v40, v41
    v_cvt_pk_bf16_f32 v53, v42, v43
    v_cvt_pk_bf16_f32 v54, v44, v45
    v_cvt_pk_bf16_f32 v55, v46, v47
    buffer_store_dwordx4 v[48:51], v215, s[20:23], s62 offen offset:2048 sc1
    buffer_store_dwordx4 v[52:55], v215, s[20:23], s62 offen offset:3072 sc1
    s_add_u32 s62, s62, 0x1000
    v_accvgpr_read_b32 v0, a64
    v_accvgpr_read_b32 v1, a65
    v_accvgpr_read_b32 v2, a66
    v_accvgpr_read_b32 v3, a67
    v_accvgpr_read_b32 v4, a68
    v_accvgpr_read_b32 v5, a69
    v_accvgpr_read_b32 v6, a70
    v_accvgpr_read_b32 v7, a71
    v_accvgpr_read_b32 v8, a72
    v_accvgpr_read_b32 v9, a73
    v_accvgpr_read_b32 v10, a74
    v_accvgpr_read_b32 v11, a75
    v_accvgpr_read_b32 v12, a76
    v_accvgpr_read_b32 v13, a77
    v_accvgpr_read_b32 v14, a78
    v_accvgpr_read_b32 v15, a79
    v_cvt_pk_bf16_f32 v16, v0, v1
    v_cvt_pk_bf16_f32 v17, v2, v3
    v_cvt_pk_bf16_f32 v18, v4, v5
    v_cvt_pk_bf16_f32 v19, v6, v7
    v_cvt_pk_bf16_f32 v20, v8, v9
    v_cvt_pk_bf16_f32 v21, v10, v11
    v_cvt_pk_bf16_f32 v22, v12, v13
    v_cvt_pk_bf16_f32 v23, v14, v15
    buffer_store_dwordx4 v[16:19], v215, s[20:23], s62 offen offset:0 sc1
    buffer_store_dwordx4 v[20:23], v215, s[20:23], s62 offen offset:1024 sc1
    v_accvgpr_read_b32 v32, a80
    v_accvgpr_read_b32 v33, a81
    v_accvgpr_read_b32 v34, a82
    v_accvgpr_read_b32 v35, a83
    v_accvgpr_read_b32 v36, a84
    v_accvgpr_read_b32 v37, a85
    v_accvgpr_read_b32 v38, a86
    v_accvgpr_read_b32 v39, a87
    v_accvgpr_read_b32 v40, a88
    v_accvgpr_read_b32 v41, a89
    v_accvgpr_read_b32 v42, a90
    v_accvgpr_read_b32 v43, a91
    v_accvgpr_read_b32 v44, a92
    v_accvgpr_read_b32 v45, a93
    v_accvgpr_read_b32 v46, a94
    v_accvgpr_read_b32 v47, a95
    v_cvt_pk_bf16_f32 v48, v32, v33
    v_cvt_pk_bf16_f32 v49, v34, v35
    v_cvt_pk_bf16_f32 v50, v36, v37
    v_cvt_pk_bf16_f32 v51, v38, v39
    v_cvt_pk_bf16_f32 v52, v40, v41
    v_cvt_pk_bf16_f32 v53, v42, v43
    v_cvt_pk_bf16_f32 v54, v44, v45
    v_cvt_pk_bf16_f32 v55, v46, v47
    buffer_store_dwordx4 v[48:51], v215, s[20:23], s62 offen offset:2048 sc1
    buffer_store_dwordx4 v[52:55], v215, s[20:23], s62 offen offset:3072 sc1
    s_add_u32 s62, s62, 0x1000
    v_accvgpr_read_b32 v0, a96
    v_accvgpr_read_b32 v1, a97
    v_accvgpr_read_b32 v2, a98
    v_accvgpr_read_b32 v3, a99
    v_accvgpr_read_b32 v4, a100
    v_accvgpr_read_b32 v5, a101
    v_accvgpr_read_b32 v6, a102
    v_accvgpr_read_b32 v7, a103
    v_accvgpr_read_b32 v8, a104
    v_accvgpr_read_b32 v9, a105
    v_accvgpr_read_b32 v10, a106
    v_accvgpr_read_b32 v11, a107
    v_accvgpr_read_b32 v12, a108
    v_accvgpr_read_b32 v13, a109
    v_accvgpr_read_b32 v14, a110
    v_accvgpr_read_b32 v15, a111
    v_cvt_pk_bf16_f32 v16, v0, v1
    v_cvt_pk_bf16_f32 v17, v2, v3
    v_cvt_pk_bf16_f32 v18, v4, v5
    v_cvt_pk_bf16_f32 v19, v6, v7
    v_cvt_pk_bf16_f32 v20, v8, v9
    v_cvt_pk_bf16_f32 v21, v10, v11
    v_cvt_pk_bf16_f32 v22, v12, v13
    v_cvt_pk_bf16_f32 v23, v14, v15
    buffer_store_dwordx4 v[16:19], v215, s[20:23], s62 offen offset:0 sc1
    buffer_store_dwordx4 v[20:23], v215, s[20:23], s62 offen offset:1024 sc1
    v_accvgpr_read_b32 v32, a112
    v_accvgpr_read_b32 v33, a113
    v_accvgpr_read_b32 v34, a114
    v_accvgpr_read_b32 v35, a115
    v_accvgpr_read_b32 v36, a116
    v_accvgpr_read_b32 v37, a117
    v_accvgpr_read_b32 v38, a118
    v_accvgpr_read_b32 v39, a119
    v_accvgpr_read_b32 v40, a120
    v_accvgpr_read_b32 v41, a121
    v_accvgpr_read_b32 v42, a122
    v_accvgpr_read_b32 v43, a123
    v_accvgpr_read_b32 v44, a124
    v_accvgpr_read_b32 v45, a125
    v_accvgpr_read_b32 v46, a126
    v_accvgpr_read_b32 v47, a127
    v_cvt_pk_bf16_f32 v48, v32, v33
    v_cvt_pk_bf16_f32 v49, v34, v35
    v_cvt_pk_bf16_f32 v50, v36, v37
    v_cvt_pk_bf16_f32 v51, v38, v39
    v_cvt_pk_bf16_f32 v52, v40, v41
    v_cvt_pk_bf16_f32 v53, v42, v43
    v_cvt_pk_bf16_f32 v54, v44, v45
    v_cvt_pk_bf16_f32 v55, v46, v47
    buffer_store_dwordx4 v[48:51], v215, s[20:23], s62 offen offset:2048 sc1
    buffer_store_dwordx4 v[52:55], v215, s[20:23], s62 offen offset:3072 sc1
    s_add_u32 s62, s62, 0x1000
    buffer_store_dword v200, v215, s[20:23], s62 offen sc1
    buffer_store_dword v201, v215, s[20:23], s62 offen offset:4 sc1
    s_mov_b32 s69, 1
    s_branch .Lswitch
.Lcombine:
    s_cmp_eq_u32 s70, 1
    s_cbranch_scc1 .Lready
    s_lshl_b32 s57, s59, 2
    s_add_u32 s57, s57, s60
    s_and_b32 s63, s57, 31
    s_lshr_b32 s57, s57, 5
    s_lshl_b32 s57, s57, 2
    s_add_u32 s57, s57, 64
    v_mov_b32 v213, s57
    s_lshl_b32 s58, 1, s63
    v_mov_b32 v217, s58
.Lpoll:
    buffer_load_dword v227, v213, s[24:27], 0 offen sc0 sc1
    s_waitcnt vmcnt(0)
    v_readfirstlane_b32 s61, v227
    s_nop 3
    s_lshr_b32 s61, s61, s63
    s_and_b32 s61, s61, 1
    s_cmp_lg_u32 s61, 0
    s_cbranch_scc1 .Lpolldone
    s_sleep 8
    s_branch .Lpoll
.Lpolldone:
    s_mov_b32 s62, 0
    buffer_load_dwordx4 a[192:195], v215, s[20:23], s62 offen offset:0 sc1
    buffer_load_dwordx4 a[196:199], v215, s[20:23], s62 offen offset:1024 sc1
    buffer_load_dwordx4 a[200:203], v215, s[20:23], s62 offen offset:2048 sc1
    buffer_load_dwordx4 a[204:207], v215, s[20:23], s62 offen offset:3072 sc1
    s_add_u32 s62, s62, 0x1000
    buffer_load_dwordx4 a[208:211], v215, s[20:23], s62 offen offset:0 sc1
    buffer_load_dwordx4 a[212:215], v215, s[20:23], s62 offen offset:1024 sc1
    buffer_load_dwordx4 a[216:219], v215, s[20:23], s62 offen offset:2048 sc1
    buffer_load_dwordx4 a[220:223], v215, s[20:23], s62 offen offset:3072 sc1
    s_add_u32 s62, s62, 0x1000
    buffer_load_dwordx4 a[224:227], v215, s[20:23], s62 offen offset:0 sc1
    buffer_load_dwordx4 a[228:231], v215, s[20:23], s62 offen offset:1024 sc1
    buffer_load_dwordx4 a[232:235], v215, s[20:23], s62 offen offset:2048 sc1
    buffer_load_dwordx4 a[236:239], v215, s[20:23], s62 offen offset:3072 sc1
    s_add_u32 s62, s62, 0x1000
    buffer_load_dwordx4 a[240:243], v215, s[20:23], s62 offen offset:0 sc1
    buffer_load_dwordx4 a[244:247], v215, s[20:23], s62 offen offset:1024 sc1
    buffer_load_dwordx4 a[248:251], v215, s[20:23], s62 offen offset:2048 sc1
    buffer_load_dwordx4 a[252:255], v215, s[20:23], s62 offen offset:3072 sc1
    s_add_u32 s62, s62, 0x1000
    buffer_load_dword v225, v215, s[20:23], s62 offen sc1
    buffer_load_dword v226, v215, s[20:23], s62 offen offset:4 sc1
.Lready:
    s_waitcnt vmcnt(0)
    v_max_f32 v213, v201, v226
    v_sub_f32 v217, v201, v213
    v_sub_f32 v212, v226, v213
    v_mul_f32 v217, s28, v217
    v_mul_f32 v212, s28, v212
    v_exp_f32 v217, v217
    v_exp_f32 v212, v212
    s_nop 0
    v_mul_f32 v200, v200, v217
    v_fma_f32 v200, v225, v212, v200
    v_rcp_f32 v211, v200
    s_nop 0
    v_mul_f32 v216, v217, v211
    v_mul_f32 v228, v212, v211
    s_add_u32 s57, s29, 0x20000
    v_and_b32 v211, 31, v210
    v_lshrrev_b32 v212, 5, v210
    v_and_b32 v213, 15, v210
    v_xor_b32 v213, v213, v212
    v_lshl_add_u32 v211, v211, 8, s57
    v_xor_b32 v96, 0, v213
    v_lshl_add_u32 v96, v96, 4, v211
    v_xor_b32 v97, 2, v213
    v_lshl_add_u32 v97, v97, 4, v211
    v_xor_b32 v98, 4, v213
    v_lshl_add_u32 v98, v98, 4, v211
    v_xor_b32 v99, 6, v213
    v_lshl_add_u32 v99, v99, 4, v211
    v_xor_b32 v100, 8, v213
    v_lshl_add_u32 v100, v100, 4, v211
    v_xor_b32 v101, 10, v213
    v_lshl_add_u32 v101, v101, 4, v211
    v_xor_b32 v102, 12, v213
    v_lshl_add_u32 v102, v102, 4, v211
    v_xor_b32 v103, 14, v213
    v_lshl_add_u32 v103, v103, 4, v211
    v_lshrrev_b32 v212, 4, v210
    v_and_b32 v213, 15, v210
    v_add_u32 v104, 0, v212
    v_xor_b32 v217, v104, v213
    v_lshlrev_b32 v217, 4, v217
    v_lshl_add_u32 v104, v104, 8, v217
    v_add_u32 v104, s57, v104
    v_add_u32 v105, 4, v212
    v_xor_b32 v217, v105, v213
    v_lshlrev_b32 v217, 4, v217
    v_lshl_add_u32 v105, v105, 8, v217
    v_add_u32 v105, s57, v105
    v_add_u32 v106, 8, v212
    v_xor_b32 v217, v106, v213
    v_lshlrev_b32 v217, 4, v217
    v_lshl_add_u32 v106, v106, 8, v217
    v_add_u32 v106, s57, v106
    v_add_u32 v107, 12, v212
    v_xor_b32 v217, v107, v213
    v_lshlrev_b32 v217, 4, v217
    v_lshl_add_u32 v107, v107, 8, v217
    v_add_u32 v107, s57, v107
    s_lshl_b32 s58, s60, 14
    v_lshlrev_b32 v108, 9, v212
    v_lshl_add_u32 v108, v213, 4, v108
    v_add_u32 v108, s58, v108
    v_accvgpr_read_b32 v0, a0
    v_accvgpr_read_b32 v1, a1
    v_accvgpr_read_b32 v2, a2
    v_accvgpr_read_b32 v3, a3
    v_accvgpr_read_b32 v4, a4
    v_accvgpr_read_b32 v5, a5
    v_accvgpr_read_b32 v6, a6
    v_accvgpr_read_b32 v7, a7
    v_accvgpr_read_b32 v8, a8
    v_accvgpr_read_b32 v9, a9
    v_accvgpr_read_b32 v10, a10
    v_accvgpr_read_b32 v11, a11
    v_accvgpr_read_b32 v12, a12
    v_accvgpr_read_b32 v13, a13
    v_accvgpr_read_b32 v14, a14
    v_accvgpr_read_b32 v15, a15
    v_accvgpr_read_b32 v16, a192
    v_accvgpr_read_b32 v17, a193
    v_accvgpr_read_b32 v18, a194
    v_accvgpr_read_b32 v19, a195
    v_accvgpr_read_b32 v20, a196
    v_accvgpr_read_b32 v21, a197
    v_accvgpr_read_b32 v22, a198
    v_accvgpr_read_b32 v23, a199
    v_mul_f32 v0, v0, v216
    v_mul_f32 v1, v1, v216
    v_mul_f32 v2, v2, v216
    v_mul_f32 v3, v3, v216
    v_mul_f32 v4, v4, v216
    v_mul_f32 v5, v5, v216
    v_mul_f32 v6, v6, v216
    v_mul_f32 v7, v7, v216
    v_mul_f32 v8, v8, v216
    v_mul_f32 v9, v9, v216
    v_mul_f32 v10, v10, v216
    v_mul_f32 v11, v11, v216
    v_mul_f32 v12, v12, v216
    v_mul_f32 v13, v13, v216
    v_mul_f32 v14, v14, v216
    v_mul_f32 v15, v15, v216
    v_lshlrev_b32 v184, 16, v16
    v_and_b32 v192, 0xffff0000, v16
    v_lshlrev_b32 v185, 16, v17
    v_and_b32 v193, 0xffff0000, v17
    v_lshlrev_b32 v186, 16, v18
    v_and_b32 v194, 0xffff0000, v18
    v_lshlrev_b32 v187, 16, v19
    v_and_b32 v195, 0xffff0000, v19
    v_lshlrev_b32 v188, 16, v20
    v_and_b32 v196, 0xffff0000, v20
    v_lshlrev_b32 v189, 16, v21
    v_and_b32 v197, 0xffff0000, v21
    v_lshlrev_b32 v190, 16, v22
    v_and_b32 v198, 0xffff0000, v22
    v_lshlrev_b32 v191, 16, v23
    v_and_b32 v199, 0xffff0000, v23
    v_fma_f32 v0, v184, v228, v0
    v_fma_f32 v1, v192, v228, v1
    v_fma_f32 v2, v185, v228, v2
    v_fma_f32 v3, v193, v228, v3
    v_fma_f32 v4, v186, v228, v4
    v_fma_f32 v5, v194, v228, v5
    v_fma_f32 v6, v187, v228, v6
    v_fma_f32 v7, v195, v228, v7
    v_fma_f32 v8, v188, v228, v8
    v_fma_f32 v9, v196, v228, v9
    v_fma_f32 v10, v189, v228, v10
    v_fma_f32 v11, v197, v228, v11
    v_fma_f32 v12, v190, v228, v12
    v_fma_f32 v13, v198, v228, v13
    v_fma_f32 v14, v191, v228, v14
    v_fma_f32 v15, v199, v228, v15
    v_cvt_pk_bf16_f32 v16, v0, v1
    v_cvt_pk_bf16_f32 v17, v2, v3
    v_cvt_pk_bf16_f32 v18, v4, v5
    v_cvt_pk_bf16_f32 v19, v6, v7
    v_cvt_pk_bf16_f32 v20, v8, v9
    v_cvt_pk_bf16_f32 v21, v10, v11
    v_cvt_pk_bf16_f32 v22, v12, v13
    v_cvt_pk_bf16_f32 v23, v14, v15
    s_nop 1
    v_permlane32_swap_b32 v16, v18
    v_permlane32_swap_b32 v17, v19
    v_permlane32_swap_b32 v20, v22
    v_permlane32_swap_b32 v21, v23
    ds_write_b128 v96, v[16:19]
    ds_write_b128 v97, v[20:23]
    v_accvgpr_read_b32 v32, a16
    v_accvgpr_read_b32 v33, a17
    v_accvgpr_read_b32 v34, a18
    v_accvgpr_read_b32 v35, a19
    v_accvgpr_read_b32 v36, a20
    v_accvgpr_read_b32 v37, a21
    v_accvgpr_read_b32 v38, a22
    v_accvgpr_read_b32 v39, a23
    v_accvgpr_read_b32 v40, a24
    v_accvgpr_read_b32 v41, a25
    v_accvgpr_read_b32 v42, a26
    v_accvgpr_read_b32 v43, a27
    v_accvgpr_read_b32 v44, a28
    v_accvgpr_read_b32 v45, a29
    v_accvgpr_read_b32 v46, a30
    v_accvgpr_read_b32 v47, a31
    v_accvgpr_read_b32 v48, a200
    v_accvgpr_read_b32 v49, a201
    v_accvgpr_read_b32 v50, a202
    v_accvgpr_read_b32 v51, a203
    v_accvgpr_read_b32 v52, a204
    v_accvgpr_read_b32 v53, a205
    v_accvgpr_read_b32 v54, a206
    v_accvgpr_read_b32 v55, a207
    v_mul_f32 v32, v32, v216
    v_mul_f32 v33, v33, v216
    v_mul_f32 v34, v34, v216
    v_mul_f32 v35, v35, v216
    v_mul_f32 v36, v36, v216
    v_mul_f32 v37, v37, v216
    v_mul_f32 v38, v38, v216
    v_mul_f32 v39, v39, v216
    v_mul_f32 v40, v40, v216
    v_mul_f32 v41, v41, v216
    v_mul_f32 v42, v42, v216
    v_mul_f32 v43, v43, v216
    v_mul_f32 v44, v44, v216
    v_mul_f32 v45, v45, v216
    v_mul_f32 v46, v46, v216
    v_mul_f32 v47, v47, v216
    v_lshlrev_b32 v184, 16, v48
    v_and_b32 v192, 0xffff0000, v48
    v_lshlrev_b32 v185, 16, v49
    v_and_b32 v193, 0xffff0000, v49
    v_lshlrev_b32 v186, 16, v50
    v_and_b32 v194, 0xffff0000, v50
    v_lshlrev_b32 v187, 16, v51
    v_and_b32 v195, 0xffff0000, v51
    v_lshlrev_b32 v188, 16, v52
    v_and_b32 v196, 0xffff0000, v52
    v_lshlrev_b32 v189, 16, v53
    v_and_b32 v197, 0xffff0000, v53
    v_lshlrev_b32 v190, 16, v54
    v_and_b32 v198, 0xffff0000, v54
    v_lshlrev_b32 v191, 16, v55
    v_and_b32 v199, 0xffff0000, v55
    v_fma_f32 v32, v184, v228, v32
    v_fma_f32 v33, v192, v228, v33
    v_fma_f32 v34, v185, v228, v34
    v_fma_f32 v35, v193, v228, v35
    v_fma_f32 v36, v186, v228, v36
    v_fma_f32 v37, v194, v228, v37
    v_fma_f32 v38, v187, v228, v38
    v_fma_f32 v39, v195, v228, v39
    v_fma_f32 v40, v188, v228, v40
    v_fma_f32 v41, v196, v228, v41
    v_fma_f32 v42, v189, v228, v42
    v_fma_f32 v43, v197, v228, v43
    v_fma_f32 v44, v190, v228, v44
    v_fma_f32 v45, v198, v228, v45
    v_fma_f32 v46, v191, v228, v46
    v_fma_f32 v47, v199, v228, v47
    v_cvt_pk_bf16_f32 v48, v32, v33
    v_cvt_pk_bf16_f32 v49, v34, v35
    v_cvt_pk_bf16_f32 v50, v36, v37
    v_cvt_pk_bf16_f32 v51, v38, v39
    v_cvt_pk_bf16_f32 v52, v40, v41
    v_cvt_pk_bf16_f32 v53, v42, v43
    v_cvt_pk_bf16_f32 v54, v44, v45
    v_cvt_pk_bf16_f32 v55, v46, v47
    s_nop 1
    v_permlane32_swap_b32 v48, v50
    v_permlane32_swap_b32 v49, v51
    v_permlane32_swap_b32 v52, v54
    v_permlane32_swap_b32 v53, v55
    ds_write_b128 v98, v[48:51]
    ds_write_b128 v99, v[52:55]
    v_accvgpr_read_b32 v0, a32
    v_accvgpr_read_b32 v1, a33
    v_accvgpr_read_b32 v2, a34
    v_accvgpr_read_b32 v3, a35
    v_accvgpr_read_b32 v4, a36
    v_accvgpr_read_b32 v5, a37
    v_accvgpr_read_b32 v6, a38
    v_accvgpr_read_b32 v7, a39
    v_accvgpr_read_b32 v8, a40
    v_accvgpr_read_b32 v9, a41
    v_accvgpr_read_b32 v10, a42
    v_accvgpr_read_b32 v11, a43
    v_accvgpr_read_b32 v12, a44
    v_accvgpr_read_b32 v13, a45
    v_accvgpr_read_b32 v14, a46
    v_accvgpr_read_b32 v15, a47
    v_accvgpr_read_b32 v16, a208
    v_accvgpr_read_b32 v17, a209
    v_accvgpr_read_b32 v18, a210
    v_accvgpr_read_b32 v19, a211
    v_accvgpr_read_b32 v20, a212
    v_accvgpr_read_b32 v21, a213
    v_accvgpr_read_b32 v22, a214
    v_accvgpr_read_b32 v23, a215
    v_mul_f32 v0, v0, v216
    v_mul_f32 v1, v1, v216
    v_mul_f32 v2, v2, v216
    v_mul_f32 v3, v3, v216
    v_mul_f32 v4, v4, v216
    v_mul_f32 v5, v5, v216
    v_mul_f32 v6, v6, v216
    v_mul_f32 v7, v7, v216
    v_mul_f32 v8, v8, v216
    v_mul_f32 v9, v9, v216
    v_mul_f32 v10, v10, v216
    v_mul_f32 v11, v11, v216
    v_mul_f32 v12, v12, v216
    v_mul_f32 v13, v13, v216
    v_mul_f32 v14, v14, v216
    v_mul_f32 v15, v15, v216
    v_lshlrev_b32 v184, 16, v16
    v_and_b32 v192, 0xffff0000, v16
    v_lshlrev_b32 v185, 16, v17
    v_and_b32 v193, 0xffff0000, v17
    v_lshlrev_b32 v186, 16, v18
    v_and_b32 v194, 0xffff0000, v18
    v_lshlrev_b32 v187, 16, v19
    v_and_b32 v195, 0xffff0000, v19
    v_lshlrev_b32 v188, 16, v20
    v_and_b32 v196, 0xffff0000, v20
    v_lshlrev_b32 v189, 16, v21
    v_and_b32 v197, 0xffff0000, v21
    v_lshlrev_b32 v190, 16, v22
    v_and_b32 v198, 0xffff0000, v22
    v_lshlrev_b32 v191, 16, v23
    v_and_b32 v199, 0xffff0000, v23
    v_fma_f32 v0, v184, v228, v0
    v_fma_f32 v1, v192, v228, v1
    v_fma_f32 v2, v185, v228, v2
    v_fma_f32 v3, v193, v228, v3
    v_fma_f32 v4, v186, v228, v4
    v_fma_f32 v5, v194, v228, v5
    v_fma_f32 v6, v187, v228, v6
    v_fma_f32 v7, v195, v228, v7
    v_fma_f32 v8, v188, v228, v8
    v_fma_f32 v9, v196, v228, v9
    v_fma_f32 v10, v189, v228, v10
    v_fma_f32 v11, v197, v228, v11
    v_fma_f32 v12, v190, v228, v12
    v_fma_f32 v13, v198, v228, v13
    v_fma_f32 v14, v191, v228, v14
    v_fma_f32 v15, v199, v228, v15
    v_cvt_pk_bf16_f32 v16, v0, v1
    v_cvt_pk_bf16_f32 v17, v2, v3
    v_cvt_pk_bf16_f32 v18, v4, v5
    v_cvt_pk_bf16_f32 v19, v6, v7
    v_cvt_pk_bf16_f32 v20, v8, v9
    v_cvt_pk_bf16_f32 v21, v10, v11
    v_cvt_pk_bf16_f32 v22, v12, v13
    v_cvt_pk_bf16_f32 v23, v14, v15
    s_nop 1
    v_permlane32_swap_b32 v16, v18
    v_permlane32_swap_b32 v17, v19
    v_permlane32_swap_b32 v20, v22
    v_permlane32_swap_b32 v21, v23
    ds_write_b128 v100, v[16:19]
    ds_write_b128 v101, v[20:23]
    v_accvgpr_read_b32 v32, a48
    v_accvgpr_read_b32 v33, a49
    v_accvgpr_read_b32 v34, a50
    v_accvgpr_read_b32 v35, a51
    v_accvgpr_read_b32 v36, a52
    v_accvgpr_read_b32 v37, a53
    v_accvgpr_read_b32 v38, a54
    v_accvgpr_read_b32 v39, a55
    v_accvgpr_read_b32 v40, a56
    v_accvgpr_read_b32 v41, a57
    v_accvgpr_read_b32 v42, a58
    v_accvgpr_read_b32 v43, a59
    v_accvgpr_read_b32 v44, a60
    v_accvgpr_read_b32 v45, a61
    v_accvgpr_read_b32 v46, a62
    v_accvgpr_read_b32 v47, a63
    v_accvgpr_read_b32 v48, a216
    v_accvgpr_read_b32 v49, a217
    v_accvgpr_read_b32 v50, a218
    v_accvgpr_read_b32 v51, a219
    v_accvgpr_read_b32 v52, a220
    v_accvgpr_read_b32 v53, a221
    v_accvgpr_read_b32 v54, a222
    v_accvgpr_read_b32 v55, a223
    v_mul_f32 v32, v32, v216
    v_mul_f32 v33, v33, v216
    v_mul_f32 v34, v34, v216
    v_mul_f32 v35, v35, v216
    v_mul_f32 v36, v36, v216
    v_mul_f32 v37, v37, v216
    v_mul_f32 v38, v38, v216
    v_mul_f32 v39, v39, v216
    v_mul_f32 v40, v40, v216
    v_mul_f32 v41, v41, v216
    v_mul_f32 v42, v42, v216
    v_mul_f32 v43, v43, v216
    v_mul_f32 v44, v44, v216
    v_mul_f32 v45, v45, v216
    v_mul_f32 v46, v46, v216
    v_mul_f32 v47, v47, v216
    v_lshlrev_b32 v184, 16, v48
    v_and_b32 v192, 0xffff0000, v48
    v_lshlrev_b32 v185, 16, v49
    v_and_b32 v193, 0xffff0000, v49
    v_lshlrev_b32 v186, 16, v50
    v_and_b32 v194, 0xffff0000, v50
    v_lshlrev_b32 v187, 16, v51
    v_and_b32 v195, 0xffff0000, v51
    v_lshlrev_b32 v188, 16, v52
    v_and_b32 v196, 0xffff0000, v52
    v_lshlrev_b32 v189, 16, v53
    v_and_b32 v197, 0xffff0000, v53
    v_lshlrev_b32 v190, 16, v54
    v_and_b32 v198, 0xffff0000, v54
    v_lshlrev_b32 v191, 16, v55
    v_and_b32 v199, 0xffff0000, v55
    v_fma_f32 v32, v184, v228, v32
    v_fma_f32 v33, v192, v228, v33
    v_fma_f32 v34, v185, v228, v34
    v_fma_f32 v35, v193, v228, v35
    v_fma_f32 v36, v186, v228, v36
    v_fma_f32 v37, v194, v228, v37
    v_fma_f32 v38, v187, v228, v38
    v_fma_f32 v39, v195, v228, v39
    v_fma_f32 v40, v188, v228, v40
    v_fma_f32 v41, v196, v228, v41
    v_fma_f32 v42, v189, v228, v42
    v_fma_f32 v43, v197, v228, v43
    v_fma_f32 v44, v190, v228, v44
    v_fma_f32 v45, v198, v228, v45
    v_fma_f32 v46, v191, v228, v46
    v_fma_f32 v47, v199, v228, v47
    v_cvt_pk_bf16_f32 v48, v32, v33
    v_cvt_pk_bf16_f32 v49, v34, v35
    v_cvt_pk_bf16_f32 v50, v36, v37
    v_cvt_pk_bf16_f32 v51, v38, v39
    v_cvt_pk_bf16_f32 v52, v40, v41
    v_cvt_pk_bf16_f32 v53, v42, v43
    v_cvt_pk_bf16_f32 v54, v44, v45
    v_cvt_pk_bf16_f32 v55, v46, v47
    s_nop 1
    v_permlane32_swap_b32 v48, v50
    v_permlane32_swap_b32 v49, v51
    v_permlane32_swap_b32 v52, v54
    v_permlane32_swap_b32 v53, v55
    ds_write_b128 v102, v[48:51]
    ds_write_b128 v103, v[52:55]
    ds_read_b128 v[112:115], v104 offset:0
    ds_read_b128 v[116:119], v105 offset:0
    ds_read_b128 v[120:123], v106 offset:0
    ds_read_b128 v[124:127], v107 offset:0
    ds_read_b128 v[128:131], v104 offset:4096
    ds_read_b128 v[132:135], v105 offset:4096
    ds_read_b128 v[136:139], v106 offset:4096
    ds_read_b128 v[140:143], v107 offset:4096
    s_mov_b32 s62, s50
    s_waitcnt lgkmcnt(7)
    buffer_store_dwordx4 v[112:115], v108, s[16:19], s62 offen offset:0 sc0 sc1
    s_add_u32 s62, s62, 0x800
    s_waitcnt lgkmcnt(6)
    buffer_store_dwordx4 v[116:119], v108, s[16:19], s62 offen offset:0 sc0 sc1
    s_add_u32 s62, s62, 0x800
    s_waitcnt lgkmcnt(5)
    buffer_store_dwordx4 v[120:123], v108, s[16:19], s62 offen offset:0 sc0 sc1
    s_add_u32 s62, s62, 0x800
    s_waitcnt lgkmcnt(4)
    buffer_store_dwordx4 v[124:127], v108, s[16:19], s62 offen offset:0 sc0 sc1
    s_add_u32 s62, s62, 0x800
    s_waitcnt lgkmcnt(3)
    buffer_store_dwordx4 v[128:131], v108, s[16:19], s62 offen offset:0 sc0 sc1
    s_add_u32 s62, s62, 0x800
    s_waitcnt lgkmcnt(2)
    buffer_store_dwordx4 v[132:135], v108, s[16:19], s62 offen offset:0 sc0 sc1
    s_add_u32 s62, s62, 0x800
    s_waitcnt lgkmcnt(1)
    buffer_store_dwordx4 v[136:139], v108, s[16:19], s62 offen offset:0 sc0 sc1
    s_add_u32 s62, s62, 0x800
    s_waitcnt lgkmcnt(0)
    buffer_store_dwordx4 v[140:143], v108, s[16:19], s62 offen offset:0 sc0 sc1
    v_accvgpr_read_b32 v0, a64
    v_accvgpr_read_b32 v1, a65
    v_accvgpr_read_b32 v2, a66
    v_accvgpr_read_b32 v3, a67
    v_accvgpr_read_b32 v4, a68
    v_accvgpr_read_b32 v5, a69
    v_accvgpr_read_b32 v6, a70
    v_accvgpr_read_b32 v7, a71
    v_accvgpr_read_b32 v8, a72
    v_accvgpr_read_b32 v9, a73
    v_accvgpr_read_b32 v10, a74
    v_accvgpr_read_b32 v11, a75
    v_accvgpr_read_b32 v12, a76
    v_accvgpr_read_b32 v13, a77
    v_accvgpr_read_b32 v14, a78
    v_accvgpr_read_b32 v15, a79
    v_accvgpr_read_b32 v16, a224
    v_accvgpr_read_b32 v17, a225
    v_accvgpr_read_b32 v18, a226
    v_accvgpr_read_b32 v19, a227
    v_accvgpr_read_b32 v20, a228
    v_accvgpr_read_b32 v21, a229
    v_accvgpr_read_b32 v22, a230
    v_accvgpr_read_b32 v23, a231
    v_mul_f32 v0, v0, v216
    v_mul_f32 v1, v1, v216
    v_mul_f32 v2, v2, v216
    v_mul_f32 v3, v3, v216
    v_mul_f32 v4, v4, v216
    v_mul_f32 v5, v5, v216
    v_mul_f32 v6, v6, v216
    v_mul_f32 v7, v7, v216
    v_mul_f32 v8, v8, v216
    v_mul_f32 v9, v9, v216
    v_mul_f32 v10, v10, v216
    v_mul_f32 v11, v11, v216
    v_mul_f32 v12, v12, v216
    v_mul_f32 v13, v13, v216
    v_mul_f32 v14, v14, v216
    v_mul_f32 v15, v15, v216
    v_lshlrev_b32 v184, 16, v16
    v_and_b32 v192, 0xffff0000, v16
    v_lshlrev_b32 v185, 16, v17
    v_and_b32 v193, 0xffff0000, v17
    v_lshlrev_b32 v186, 16, v18
    v_and_b32 v194, 0xffff0000, v18
    v_lshlrev_b32 v187, 16, v19
    v_and_b32 v195, 0xffff0000, v19
    v_lshlrev_b32 v188, 16, v20
    v_and_b32 v196, 0xffff0000, v20
    v_lshlrev_b32 v189, 16, v21
    v_and_b32 v197, 0xffff0000, v21
    v_lshlrev_b32 v190, 16, v22
    v_and_b32 v198, 0xffff0000, v22
    v_lshlrev_b32 v191, 16, v23
    v_and_b32 v199, 0xffff0000, v23
    v_fma_f32 v0, v184, v228, v0
    v_fma_f32 v1, v192, v228, v1
    v_fma_f32 v2, v185, v228, v2
    v_fma_f32 v3, v193, v228, v3
    v_fma_f32 v4, v186, v228, v4
    v_fma_f32 v5, v194, v228, v5
    v_fma_f32 v6, v187, v228, v6
    v_fma_f32 v7, v195, v228, v7
    v_fma_f32 v8, v188, v228, v8
    v_fma_f32 v9, v196, v228, v9
    v_fma_f32 v10, v189, v228, v10
    v_fma_f32 v11, v197, v228, v11
    v_fma_f32 v12, v190, v228, v12
    v_fma_f32 v13, v198, v228, v13
    v_fma_f32 v14, v191, v228, v14
    v_fma_f32 v15, v199, v228, v15
    v_cvt_pk_bf16_f32 v16, v0, v1
    v_cvt_pk_bf16_f32 v17, v2, v3
    v_cvt_pk_bf16_f32 v18, v4, v5
    v_cvt_pk_bf16_f32 v19, v6, v7
    v_cvt_pk_bf16_f32 v20, v8, v9
    v_cvt_pk_bf16_f32 v21, v10, v11
    v_cvt_pk_bf16_f32 v22, v12, v13
    v_cvt_pk_bf16_f32 v23, v14, v15
    s_nop 1
    v_permlane32_swap_b32 v16, v18
    v_permlane32_swap_b32 v17, v19
    v_permlane32_swap_b32 v20, v22
    v_permlane32_swap_b32 v21, v23
    ds_write_b128 v96, v[16:19]
    ds_write_b128 v97, v[20:23]
    v_accvgpr_read_b32 v32, a80
    v_accvgpr_read_b32 v33, a81
    v_accvgpr_read_b32 v34, a82
    v_accvgpr_read_b32 v35, a83
    v_accvgpr_read_b32 v36, a84
    v_accvgpr_read_b32 v37, a85
    v_accvgpr_read_b32 v38, a86
    v_accvgpr_read_b32 v39, a87
    v_accvgpr_read_b32 v40, a88
    v_accvgpr_read_b32 v41, a89
    v_accvgpr_read_b32 v42, a90
    v_accvgpr_read_b32 v43, a91
    v_accvgpr_read_b32 v44, a92
    v_accvgpr_read_b32 v45, a93
    v_accvgpr_read_b32 v46, a94
    v_accvgpr_read_b32 v47, a95
    v_accvgpr_read_b32 v48, a232
    v_accvgpr_read_b32 v49, a233
    v_accvgpr_read_b32 v50, a234
    v_accvgpr_read_b32 v51, a235
    v_accvgpr_read_b32 v52, a236
    v_accvgpr_read_b32 v53, a237
    v_accvgpr_read_b32 v54, a238
    v_accvgpr_read_b32 v55, a239
    v_mul_f32 v32, v32, v216
    v_mul_f32 v33, v33, v216
    v_mul_f32 v34, v34, v216
    v_mul_f32 v35, v35, v216
    v_mul_f32 v36, v36, v216
    v_mul_f32 v37, v37, v216
    v_mul_f32 v38, v38, v216
    v_mul_f32 v39, v39, v216
    v_mul_f32 v40, v40, v216
    v_mul_f32 v41, v41, v216
    v_mul_f32 v42, v42, v216
    v_mul_f32 v43, v43, v216
    v_mul_f32 v44, v44, v216
    v_mul_f32 v45, v45, v216
    v_mul_f32 v46, v46, v216
    v_mul_f32 v47, v47, v216
    v_lshlrev_b32 v184, 16, v48
    v_and_b32 v192, 0xffff0000, v48
    v_lshlrev_b32 v185, 16, v49
    v_and_b32 v193, 0xffff0000, v49
    v_lshlrev_b32 v186, 16, v50
    v_and_b32 v194, 0xffff0000, v50
    v_lshlrev_b32 v187, 16, v51
    v_and_b32 v195, 0xffff0000, v51
    v_lshlrev_b32 v188, 16, v52
    v_and_b32 v196, 0xffff0000, v52
    v_lshlrev_b32 v189, 16, v53
    v_and_b32 v197, 0xffff0000, v53
    v_lshlrev_b32 v190, 16, v54
    v_and_b32 v198, 0xffff0000, v54
    v_lshlrev_b32 v191, 16, v55
    v_and_b32 v199, 0xffff0000, v55
    v_fma_f32 v32, v184, v228, v32
    v_fma_f32 v33, v192, v228, v33
    v_fma_f32 v34, v185, v228, v34
    v_fma_f32 v35, v193, v228, v35
    v_fma_f32 v36, v186, v228, v36
    v_fma_f32 v37, v194, v228, v37
    v_fma_f32 v38, v187, v228, v38
    v_fma_f32 v39, v195, v228, v39
    v_fma_f32 v40, v188, v228, v40
    v_fma_f32 v41, v196, v228, v41
    v_fma_f32 v42, v189, v228, v42
    v_fma_f32 v43, v197, v228, v43
    v_fma_f32 v44, v190, v228, v44
    v_fma_f32 v45, v198, v228, v45
    v_fma_f32 v46, v191, v228, v46
    v_fma_f32 v47, v199, v228, v47
    v_cvt_pk_bf16_f32 v48, v32, v33
    v_cvt_pk_bf16_f32 v49, v34, v35
    v_cvt_pk_bf16_f32 v50, v36, v37
    v_cvt_pk_bf16_f32 v51, v38, v39
    v_cvt_pk_bf16_f32 v52, v40, v41
    v_cvt_pk_bf16_f32 v53, v42, v43
    v_cvt_pk_bf16_f32 v54, v44, v45
    v_cvt_pk_bf16_f32 v55, v46, v47
    s_nop 1
    v_permlane32_swap_b32 v48, v50
    v_permlane32_swap_b32 v49, v51
    v_permlane32_swap_b32 v52, v54
    v_permlane32_swap_b32 v53, v55
    ds_write_b128 v98, v[48:51]
    ds_write_b128 v99, v[52:55]
    v_accvgpr_read_b32 v0, a96
    v_accvgpr_read_b32 v1, a97
    v_accvgpr_read_b32 v2, a98
    v_accvgpr_read_b32 v3, a99
    v_accvgpr_read_b32 v4, a100
    v_accvgpr_read_b32 v5, a101
    v_accvgpr_read_b32 v6, a102
    v_accvgpr_read_b32 v7, a103
    v_accvgpr_read_b32 v8, a104
    v_accvgpr_read_b32 v9, a105
    v_accvgpr_read_b32 v10, a106
    v_accvgpr_read_b32 v11, a107
    v_accvgpr_read_b32 v12, a108
    v_accvgpr_read_b32 v13, a109
    v_accvgpr_read_b32 v14, a110
    v_accvgpr_read_b32 v15, a111
    v_accvgpr_read_b32 v16, a240
    v_accvgpr_read_b32 v17, a241
    v_accvgpr_read_b32 v18, a242
    v_accvgpr_read_b32 v19, a243
    v_accvgpr_read_b32 v20, a244
    v_accvgpr_read_b32 v21, a245
    v_accvgpr_read_b32 v22, a246
    v_accvgpr_read_b32 v23, a247
    v_mul_f32 v0, v0, v216
    v_mul_f32 v1, v1, v216
    v_mul_f32 v2, v2, v216
    v_mul_f32 v3, v3, v216
    v_mul_f32 v4, v4, v216
    v_mul_f32 v5, v5, v216
    v_mul_f32 v6, v6, v216
    v_mul_f32 v7, v7, v216
    v_mul_f32 v8, v8, v216
    v_mul_f32 v9, v9, v216
    v_mul_f32 v10, v10, v216
    v_mul_f32 v11, v11, v216
    v_mul_f32 v12, v12, v216
    v_mul_f32 v13, v13, v216
    v_mul_f32 v14, v14, v216
    v_mul_f32 v15, v15, v216
    v_lshlrev_b32 v184, 16, v16
    v_and_b32 v192, 0xffff0000, v16
    v_lshlrev_b32 v185, 16, v17
    v_and_b32 v193, 0xffff0000, v17
    v_lshlrev_b32 v186, 16, v18
    v_and_b32 v194, 0xffff0000, v18
    v_lshlrev_b32 v187, 16, v19
    v_and_b32 v195, 0xffff0000, v19
    v_lshlrev_b32 v188, 16, v20
    v_and_b32 v196, 0xffff0000, v20
    v_lshlrev_b32 v189, 16, v21
    v_and_b32 v197, 0xffff0000, v21
    v_lshlrev_b32 v190, 16, v22
    v_and_b32 v198, 0xffff0000, v22
    v_lshlrev_b32 v191, 16, v23
    v_and_b32 v199, 0xffff0000, v23
    v_fma_f32 v0, v184, v228, v0
    v_fma_f32 v1, v192, v228, v1
    v_fma_f32 v2, v185, v228, v2
    v_fma_f32 v3, v193, v228, v3
    v_fma_f32 v4, v186, v228, v4
    v_fma_f32 v5, v194, v228, v5
    v_fma_f32 v6, v187, v228, v6
    v_fma_f32 v7, v195, v228, v7
    v_fma_f32 v8, v188, v228, v8
    v_fma_f32 v9, v196, v228, v9
    v_fma_f32 v10, v189, v228, v10
    v_fma_f32 v11, v197, v228, v11
    v_fma_f32 v12, v190, v228, v12
    v_fma_f32 v13, v198, v228, v13
    v_fma_f32 v14, v191, v228, v14
    v_fma_f32 v15, v199, v228, v15
    v_cvt_pk_bf16_f32 v16, v0, v1
    v_cvt_pk_bf16_f32 v17, v2, v3
    v_cvt_pk_bf16_f32 v18, v4, v5
    v_cvt_pk_bf16_f32 v19, v6, v7
    v_cvt_pk_bf16_f32 v20, v8, v9
    v_cvt_pk_bf16_f32 v21, v10, v11
    v_cvt_pk_bf16_f32 v22, v12, v13
    v_cvt_pk_bf16_f32 v23, v14, v15
    s_nop 1
    v_permlane32_swap_b32 v16, v18
    v_permlane32_swap_b32 v17, v19
    v_permlane32_swap_b32 v20, v22
    v_permlane32_swap_b32 v21, v23
    ds_write_b128 v100, v[16:19]
    ds_write_b128 v101, v[20:23]
    v_accvgpr_read_b32 v32, a112
    v_accvgpr_read_b32 v33, a113
    v_accvgpr_read_b32 v34, a114
    v_accvgpr_read_b32 v35, a115
    v_accvgpr_read_b32 v36, a116
    v_accvgpr_read_b32 v37, a117
    v_accvgpr_read_b32 v38, a118
    v_accvgpr_read_b32 v39, a119
    v_accvgpr_read_b32 v40, a120
    v_accvgpr_read_b32 v41, a121
    v_accvgpr_read_b32 v42, a122
    v_accvgpr_read_b32 v43, a123
    v_accvgpr_read_b32 v44, a124
    v_accvgpr_read_b32 v45, a125
    v_accvgpr_read_b32 v46, a126
    v_accvgpr_read_b32 v47, a127
    v_accvgpr_read_b32 v48, a248
    v_accvgpr_read_b32 v49, a249
    v_accvgpr_read_b32 v50, a250
    v_accvgpr_read_b32 v51, a251
    v_accvgpr_read_b32 v52, a252
    v_accvgpr_read_b32 v53, a253
    v_accvgpr_read_b32 v54, a254
    v_accvgpr_read_b32 v55, a255
    v_mul_f32 v32, v32, v216
    v_mul_f32 v33, v33, v216
    v_mul_f32 v34, v34, v216
    v_mul_f32 v35, v35, v216
    v_mul_f32 v36, v36, v216
    v_mul_f32 v37, v37, v216
    v_mul_f32 v38, v38, v216
    v_mul_f32 v39, v39, v216
    v_mul_f32 v40, v40, v216
    v_mul_f32 v41, v41, v216
    v_mul_f32 v42, v42, v216
    v_mul_f32 v43, v43, v216
    v_mul_f32 v44, v44, v216
    v_mul_f32 v45, v45, v216
    v_mul_f32 v46, v46, v216
    v_mul_f32 v47, v47, v216
    v_lshlrev_b32 v184, 16, v48
    v_and_b32 v192, 0xffff0000, v48
    v_lshlrev_b32 v185, 16, v49
    v_and_b32 v193, 0xffff0000, v49
    v_lshlrev_b32 v186, 16, v50
    v_and_b32 v194, 0xffff0000, v50
    v_lshlrev_b32 v187, 16, v51
    v_and_b32 v195, 0xffff0000, v51
    v_lshlrev_b32 v188, 16, v52
    v_and_b32 v196, 0xffff0000, v52
    v_lshlrev_b32 v189, 16, v53
    v_and_b32 v197, 0xffff0000, v53
    v_lshlrev_b32 v190, 16, v54
    v_and_b32 v198, 0xffff0000, v54
    v_lshlrev_b32 v191, 16, v55
    v_and_b32 v199, 0xffff0000, v55
    v_fma_f32 v32, v184, v228, v32
    v_fma_f32 v33, v192, v228, v33
    v_fma_f32 v34, v185, v228, v34
    v_fma_f32 v35, v193, v228, v35
    v_fma_f32 v36, v186, v228, v36
    v_fma_f32 v37, v194, v228, v37
    v_fma_f32 v38, v187, v228, v38
    v_fma_f32 v39, v195, v228, v39
    v_fma_f32 v40, v188, v228, v40
    v_fma_f32 v41, v196, v228, v41
    v_fma_f32 v42, v189, v228, v42
    v_fma_f32 v43, v197, v228, v43
    v_fma_f32 v44, v190, v228, v44
    v_fma_f32 v45, v198, v228, v45
    v_fma_f32 v46, v191, v228, v46
    v_fma_f32 v47, v199, v228, v47
    v_cvt_pk_bf16_f32 v48, v32, v33
    v_cvt_pk_bf16_f32 v49, v34, v35
    v_cvt_pk_bf16_f32 v50, v36, v37
    v_cvt_pk_bf16_f32 v51, v38, v39
    v_cvt_pk_bf16_f32 v52, v40, v41
    v_cvt_pk_bf16_f32 v53, v42, v43
    v_cvt_pk_bf16_f32 v54, v44, v45
    v_cvt_pk_bf16_f32 v55, v46, v47
    s_nop 1
    v_permlane32_swap_b32 v48, v50
    v_permlane32_swap_b32 v49, v51
    v_permlane32_swap_b32 v52, v54
    v_permlane32_swap_b32 v53, v55
    ds_write_b128 v102, v[48:51]
    ds_write_b128 v103, v[52:55]
    ds_read_b128 v[112:115], v104 offset:0
    ds_read_b128 v[116:119], v105 offset:0
    ds_read_b128 v[120:123], v106 offset:0
    ds_read_b128 v[124:127], v107 offset:0
    ds_read_b128 v[128:131], v104 offset:4096
    ds_read_b128 v[132:135], v105 offset:4096
    ds_read_b128 v[136:139], v106 offset:4096
    ds_read_b128 v[140:143], v107 offset:4096
    s_mov_b32 s62, s50
    s_waitcnt lgkmcnt(7)
    buffer_store_dwordx4 v[112:115], v108, s[16:19], s62 offen offset:256 sc0 sc1
    s_add_u32 s62, s62, 0x800
    s_waitcnt lgkmcnt(6)
    buffer_store_dwordx4 v[116:119], v108, s[16:19], s62 offen offset:256 sc0 sc1
    s_add_u32 s62, s62, 0x800
    s_waitcnt lgkmcnt(5)
    buffer_store_dwordx4 v[120:123], v108, s[16:19], s62 offen offset:256 sc0 sc1
    s_add_u32 s62, s62, 0x800
    s_waitcnt lgkmcnt(4)
    buffer_store_dwordx4 v[124:127], v108, s[16:19], s62 offen offset:256 sc0 sc1
    s_add_u32 s62, s62, 0x800
    s_waitcnt lgkmcnt(3)
    buffer_store_dwordx4 v[128:131], v108, s[16:19], s62 offen offset:256 sc0 sc1
    s_add_u32 s62, s62, 0x800
    s_waitcnt lgkmcnt(2)
    buffer_store_dwordx4 v[132:135], v108, s[16:19], s62 offen offset:256 sc0 sc1
    s_add_u32 s62, s62, 0x800
    s_waitcnt lgkmcnt(1)
    buffer_store_dwordx4 v[136:139], v108, s[16:19], s62 offen offset:256 sc0 sc1
    s_add_u32 s62, s62, 0x800
    s_waitcnt lgkmcnt(0)
    buffer_store_dwordx4 v[140:143], v108, s[16:19], s62 offen offset:256 sc0 sc1
    s_branch .Lfin
.Lrare0:
    v_max3_f32 v211, v0, v1, v2
    v_max3_f32 v212, v3, v4, v5
    v_max3_f32 v211, v211, v6, v7
    v_max3_f32 v212, v212, v8, v9
    v_max3_f32 v211, v211, v10, v11
    v_max3_f32 v212, v212, v12, v13
    v_max3_f32 v211, v211, v14, v15
    v_max3_f32 v212, v212, v16, v17
    v_max3_f32 v211, v211, v18, v19
    v_max3_f32 v212, v212, v20, v21
    v_max3_f32 v211, v211, v22, v23
    v_max3_f32 v212, v212, v24, v25
    v_max3_f32 v211, v211, v26, v27
    v_max3_f32 v212, v212, v28, v29
    v_max3_f32 v211, v211, v30, v31
    v_max_f32 v211, v211, v212
    v_mov_b32 v212, v211
    s_nop 1
    v_permlane32_swap_b32 v211, v212
    v_max_f32 v211, v211, v212
    v_max_f32 v211, v211, v201
    v_sub_f32 v212, v201, v211
    v_mul_f32 v212, s28, v212
    v_exp_f32 v216, v212
    v_mov_b32 v201, v211
    v_mul_f32 v202, s28, v201
    v_sub_f32 v202, 0, v202
    v_mul_f32 v200, v200, v216
    v_accvgpr_read_b32 v192, a0
    v_accvgpr_read_b32 v193, a1
    v_accvgpr_read_b32 v194, a2
    v_accvgpr_read_b32 v195, a3
    v_mul_f32 v192, v192, v216
    v_mul_f32 v193, v193, v216
    v_mul_f32 v194, v194, v216
    v_mul_f32 v195, v195, v216
    v_accvgpr_write_b32 a0, v192
    v_accvgpr_write_b32 a1, v193
    v_accvgpr_write_b32 a2, v194
    v_accvgpr_write_b32 a3, v195
    v_accvgpr_read_b32 v192, a4
    v_accvgpr_read_b32 v193, a5
    v_accvgpr_read_b32 v194, a6
    v_accvgpr_read_b32 v195, a7
    v_mul_f32 v192, v192, v216
    v_mul_f32 v193, v193, v216
    v_mul_f32 v194, v194, v216
    v_mul_f32 v195, v195, v216
    v_accvgpr_write_b32 a4, v192
    v_accvgpr_write_b32 a5, v193
    v_accvgpr_write_b32 a6, v194
    v_accvgpr_write_b32 a7, v195
    v_accvgpr_read_b32 v192, a8
    v_accvgpr_read_b32 v193, a9
    v_accvgpr_read_b32 v194, a10
    v_accvgpr_read_b32 v195, a11
    v_mul_f32 v192, v192, v216
    v_mul_f32 v193, v193, v216
    v_mul_f32 v194, v194, v216
    v_mul_f32 v195, v195, v216
    v_accvgpr_write_b32 a8, v192
    v_accvgpr_write_b32 a9, v193
    v_accvgpr_write_b32 a10, v194
    v_accvgpr_write_b32 a11, v195
    v_accvgpr_read_b32 v192, a12
    v_accvgpr_read_b32 v193, a13
    v_accvgpr_read_b32 v194, a14
    v_accvgpr_read_b32 v195, a15
    v_mul_f32 v192, v192, v216
    v_mul_f32 v193, v193, v216
    v_mul_f32 v194, v194, v216
    v_mul_f32 v195, v195, v216
    v_accvgpr_write_b32 a12, v192
    v_accvgpr_write_b32 a13, v193
    v_accvgpr_write_b32 a14, v194
    v_accvgpr_write_b32 a15, v195
    v_accvgpr_read_b32 v192, a16
    v_accvgpr_read_b32 v193, a17
    v_accvgpr_read_b32 v194, a18
    v_accvgpr_read_b32 v195, a19
    v_mul_f32 v192, v192, v216
    v_mul_f32 v193, v193, v216
    v_mul_f32 v194, v194, v216
    v_mul_f32 v195, v195, v216
    v_accvgpr_write_b32 a16, v192
    v_accvgpr_write_b32 a17, v193
    v_accvgpr_write_b32 a18, v194
    v_accvgpr_write_b32 a19, v195
    v_accvgpr_read_b32 v192, a20
    v_accvgpr_read_b32 v193, a21
    v_accvgpr_read_b32 v194, a22
    v_accvgpr_read_b32 v195, a23
    v_mul_f32 v192, v192, v216
    v_mul_f32 v193, v193, v216
    v_mul_f32 v194, v194, v216
    v_mul_f32 v195, v195, v216
    v_accvgpr_write_b32 a20, v192
    v_accvgpr_write_b32 a21, v193
    v_accvgpr_write_b32 a22, v194
    v_accvgpr_write_b32 a23, v195
    v_accvgpr_read_b32 v192, a24
    v_accvgpr_read_b32 v193, a25
    v_accvgpr_read_b32 v194, a26
    v_accvgpr_read_b32 v195, a27
    v_mul_f32 v192, v192, v216
    v_mul_f32 v193, v193, v216
    v_mul_f32 v194, v194, v216
    v_mul_f32 v195, v195, v216
    v_accvgpr_write_b32 a24, v192
    v_accvgpr_write_b32 a25, v193
    v_accvgpr_write_b32 a26, v194
    v_accvgpr_write_b32 a27, v195
    v_accvgpr_read_b32 v192, a28
    v_accvgpr_read_b32 v193, a29
    v_accvgpr_read_b32 v194, a30
    v_accvgpr_read_b32 v195, a31
    v_mul_f32 v192, v192, v216
    v_mul_f32 v193, v193, v216
    v_mul_f32 v194, v194, v216
    v_mul_f32 v195, v195, v216
    v_accvgpr_write_b32 a28, v192
    v_accvgpr_write_b32 a29, v193
    v_accvgpr_write_b32 a30, v194
    v_accvgpr_write_b32 a31, v195
    v_accvgpr_read_b32 v192, a32
    v_accvgpr_read_b32 v193, a33
    v_accvgpr_read_b32 v194, a34
    v_accvgpr_read_b32 v195, a35
    v_mul_f32 v192, v192, v216
    v_mul_f32 v193, v193, v216
    v_mul_f32 v194, v194, v216
    v_mul_f32 v195, v195, v216
    v_accvgpr_write_b32 a32, v192
    v_accvgpr_write_b32 a33, v193
    v_accvgpr_write_b32 a34, v194
    v_accvgpr_write_b32 a35, v195
    v_accvgpr_read_b32 v192, a36
    v_accvgpr_read_b32 v193, a37
    v_accvgpr_read_b32 v194, a38
    v_accvgpr_read_b32 v195, a39
    v_mul_f32 v192, v192, v216
    v_mul_f32 v193, v193, v216
    v_mul_f32 v194, v194, v216
    v_mul_f32 v195, v195, v216
    v_accvgpr_write_b32 a36, v192
    v_accvgpr_write_b32 a37, v193
    v_accvgpr_write_b32 a38, v194
    v_accvgpr_write_b32 a39, v195
    v_accvgpr_read_b32 v192, a40
    v_accvgpr_read_b32 v193, a41
    v_accvgpr_read_b32 v194, a42
    v_accvgpr_read_b32 v195, a43
    v_mul_f32 v192, v192, v216
    v_mul_f32 v193, v193, v216
    v_mul_f32 v194, v194, v216
    v_mul_f32 v195, v195, v216
    v_accvgpr_write_b32 a40, v192
    v_accvgpr_write_b32 a41, v193
    v_accvgpr_write_b32 a42, v194
    v_accvgpr_write_b32 a43, v195
    v_accvgpr_read_b32 v192, a44
    v_accvgpr_read_b32 v193, a45
    v_accvgpr_read_b32 v194, a46
    v_accvgpr_read_b32 v195, a47
    v_mul_f32 v192, v192, v216
    v_mul_f32 v193, v193, v216
    v_mul_f32 v194, v194, v216
    v_mul_f32 v195, v195, v216
    v_accvgpr_write_b32 a44, v192
    v_accvgpr_write_b32 a45, v193
    v_accvgpr_write_b32 a46, v194
    v_accvgpr_write_b32 a47, v195
    v_accvgpr_read_b32 v192, a48
    v_accvgpr_read_b32 v193, a49
    v_accvgpr_read_b32 v194, a50
    v_accvgpr_read_b32 v195, a51
    v_mul_f32 v192, v192, v216
    v_mul_f32 v193, v193, v216
    v_mul_f32 v194, v194, v216
    v_mul_f32 v195, v195, v216
    v_accvgpr_write_b32 a48, v192
    v_accvgpr_write_b32 a49, v193
    v_accvgpr_write_b32 a50, v194
    v_accvgpr_write_b32 a51, v195
    v_accvgpr_read_b32 v192, a52
    v_accvgpr_read_b32 v193, a53
    v_accvgpr_read_b32 v194, a54
    v_accvgpr_read_b32 v195, a55
    v_mul_f32 v192, v192, v216
    v_mul_f32 v193, v193, v216
    v_mul_f32 v194, v194, v216
    v_mul_f32 v195, v195, v216
    v_accvgpr_write_b32 a52, v192
    v_accvgpr_write_b32 a53, v193
    v_accvgpr_write_b32 a54, v194
    v_accvgpr_write_b32 a55, v195
    v_accvgpr_read_b32 v192, a56
    v_accvgpr_read_b32 v193, a57
    v_accvgpr_read_b32 v194, a58
    v_accvgpr_read_b32 v195, a59
    v_mul_f32 v192, v192, v216
    v_mul_f32 v193, v193, v216
    v_mul_f32 v194, v194, v216
    v_mul_f32 v195, v195, v216
    v_accvgpr_write_b32 a56, v192
    v_accvgpr_write_b32 a57, v193
    v_accvgpr_write_b32 a58, v194
    v_accvgpr_write_b32 a59, v195
    v_accvgpr_read_b32 v192, a60
    v_accvgpr_read_b32 v193, a61
    v_accvgpr_read_b32 v194, a62
    v_accvgpr_read_b32 v195, a63
    v_mul_f32 v192, v192, v216
    v_mul_f32 v193, v193, v216
    v_mul_f32 v194, v194, v216
    v_mul_f32 v195, v195, v216
    v_accvgpr_write_b32 a60, v192
    v_accvgpr_write_b32 a61, v193
    v_accvgpr_write_b32 a62, v194
    v_accvgpr_write_b32 a63, v195
    v_accvgpr_read_b32 v192, a64
    v_accvgpr_read_b32 v193, a65
    v_accvgpr_read_b32 v194, a66
    v_accvgpr_read_b32 v195, a67
    v_mul_f32 v192, v192, v216
    v_mul_f32 v193, v193, v216
    v_mul_f32 v194, v194, v216
    v_mul_f32 v195, v195, v216
    v_accvgpr_write_b32 a64, v192
    v_accvgpr_write_b32 a65, v193
    v_accvgpr_write_b32 a66, v194
    v_accvgpr_write_b32 a67, v195
    v_accvgpr_read_b32 v192, a68
    v_accvgpr_read_b32 v193, a69
    v_accvgpr_read_b32 v194, a70
    v_accvgpr_read_b32 v195, a71
    v_mul_f32 v192, v192, v216
    v_mul_f32 v193, v193, v216
    v_mul_f32 v194, v194, v216
    v_mul_f32 v195, v195, v216
    v_accvgpr_write_b32 a68, v192
    v_accvgpr_write_b32 a69, v193
    v_accvgpr_write_b32 a70, v194
    v_accvgpr_write_b32 a71, v195
    v_accvgpr_read_b32 v192, a72
    v_accvgpr_read_b32 v193, a73
    v_accvgpr_read_b32 v194, a74
    v_accvgpr_read_b32 v195, a75
    v_mul_f32 v192, v192, v216
    v_mul_f32 v193, v193, v216
    v_mul_f32 v194, v194, v216
    v_mul_f32 v195, v195, v216
    v_accvgpr_write_b32 a72, v192
    v_accvgpr_write_b32 a73, v193
    v_accvgpr_write_b32 a74, v194
    v_accvgpr_write_b32 a75, v195
    v_accvgpr_read_b32 v192, a76
    v_accvgpr_read_b32 v193, a77
    v_accvgpr_read_b32 v194, a78
    v_accvgpr_read_b32 v195, a79
    v_mul_f32 v192, v192, v216
    v_mul_f32 v193, v193, v216
    v_mul_f32 v194, v194, v216
    v_mul_f32 v195, v195, v216
    v_accvgpr_write_b32 a76, v192
    v_accvgpr_write_b32 a77, v193
    v_accvgpr_write_b32 a78, v194
    v_accvgpr_write_b32 a79, v195
    v_accvgpr_read_b32 v192, a80
    v_accvgpr_read_b32 v193, a81
    v_accvgpr_read_b32 v194, a82
    v_accvgpr_read_b32 v195, a83
    v_mul_f32 v192, v192, v216
    v_mul_f32 v193, v193, v216
    v_mul_f32 v194, v194, v216
    v_mul_f32 v195, v195, v216
    v_accvgpr_write_b32 a80, v192
    v_accvgpr_write_b32 a81, v193
    v_accvgpr_write_b32 a82, v194
    v_accvgpr_write_b32 a83, v195
    v_accvgpr_read_b32 v192, a84
    v_accvgpr_read_b32 v193, a85
    v_accvgpr_read_b32 v194, a86
    v_accvgpr_read_b32 v195, a87
    v_mul_f32 v192, v192, v216
    v_mul_f32 v193, v193, v216
    v_mul_f32 v194, v194, v216
    v_mul_f32 v195, v195, v216
    v_accvgpr_write_b32 a84, v192
    v_accvgpr_write_b32 a85, v193
    v_accvgpr_write_b32 a86, v194
    v_accvgpr_write_b32 a87, v195
    v_accvgpr_read_b32 v192, a88
    v_accvgpr_read_b32 v193, a89
    v_accvgpr_read_b32 v194, a90
    v_accvgpr_read_b32 v195, a91
    v_mul_f32 v192, v192, v216
    v_mul_f32 v193, v193, v216
    v_mul_f32 v194, v194, v216
    v_mul_f32 v195, v195, v216
    v_accvgpr_write_b32 a88, v192
    v_accvgpr_write_b32 a89, v193
    v_accvgpr_write_b32 a90, v194
    v_accvgpr_write_b32 a91, v195
    v_accvgpr_read_b32 v192, a92
    v_accvgpr_read_b32 v193, a93
    v_accvgpr_read_b32 v194, a94
    v_accvgpr_read_b32 v195, a95
    v_mul_f32 v192, v192, v216
    v_mul_f32 v193, v193, v216
    v_mul_f32 v194, v194, v216
    v_mul_f32 v195, v195, v216
    v_accvgpr_write_b32 a92, v192
    v_accvgpr_write_b32 a93, v193
    v_accvgpr_write_b32 a94, v194
    v_accvgpr_write_b32 a95, v195
    v_accvgpr_read_b32 v192, a96
    v_accvgpr_read_b32 v193, a97
    v_accvgpr_read_b32 v194, a98
    v_accvgpr_read_b32 v195, a99
    v_mul_f32 v192, v192, v216
    v_mul_f32 v193, v193, v216
    v_mul_f32 v194, v194, v216
    v_mul_f32 v195, v195, v216
    v_accvgpr_write_b32 a96, v192
    v_accvgpr_write_b32 a97, v193
    v_accvgpr_write_b32 a98, v194
    v_accvgpr_write_b32 a99, v195
    v_accvgpr_read_b32 v192, a100
    v_accvgpr_read_b32 v193, a101
    v_accvgpr_read_b32 v194, a102
    v_accvgpr_read_b32 v195, a103
    v_mul_f32 v192, v192, v216
    v_mul_f32 v193, v193, v216
    v_mul_f32 v194, v194, v216
    v_mul_f32 v195, v195, v216
    v_accvgpr_write_b32 a100, v192
    v_accvgpr_write_b32 a101, v193
    v_accvgpr_write_b32 a102, v194
    v_accvgpr_write_b32 a103, v195
    v_accvgpr_read_b32 v192, a104
    v_accvgpr_read_b32 v193, a105
    v_accvgpr_read_b32 v194, a106
    v_accvgpr_read_b32 v195, a107
    v_mul_f32 v192, v192, v216
    v_mul_f32 v193, v193, v216
    v_mul_f32 v194, v194, v216
    v_mul_f32 v195, v195, v216
    v_accvgpr_write_b32 a104, v192
    v_accvgpr_write_b32 a105, v193
    v_accvgpr_write_b32 a106, v194
    v_accvgpr_write_b32 a107, v195
    v_accvgpr_read_b32 v192, a108
    v_accvgpr_read_b32 v193, a109
    v_accvgpr_read_b32 v194, a110
    v_accvgpr_read_b32 v195, a111
    v_mul_f32 v192, v192, v216
    v_mul_f32 v193, v193, v216
    v_mul_f32 v194, v194, v216
    v_mul_f32 v195, v195, v216
    v_accvgpr_write_b32 a108, v192
    v_accvgpr_write_b32 a109, v193
    v_accvgpr_write_b32 a110, v194
    v_accvgpr_write_b32 a111, v195
    v_accvgpr_read_b32 v192, a112
    v_accvgpr_read_b32 v193, a113
    v_accvgpr_read_b32 v194, a114
    v_accvgpr_read_b32 v195, a115
    v_mul_f32 v192, v192, v216
    v_mul_f32 v193, v193, v216
    v_mul_f32 v194, v194, v216
    v_mul_f32 v195, v195, v216
    v_accvgpr_write_b32 a112, v192
    v_accvgpr_write_b32 a113, v193
    v_accvgpr_write_b32 a114, v194
    v_accvgpr_write_b32 a115, v195
    v_accvgpr_read_b32 v192, a116
    v_accvgpr_read_b32 v193, a117
    v_accvgpr_read_b32 v194, a118
    v_accvgpr_read_b32 v195, a119
    v_mul_f32 v192, v192, v216
    v_mul_f32 v193, v193, v216
    v_mul_f32 v194, v194, v216
    v_mul_f32 v195, v195, v216
    v_accvgpr_write_b32 a116, v192
    v_accvgpr_write_b32 a117, v193
    v_accvgpr_write_b32 a118, v194
    v_accvgpr_write_b32 a119, v195
    v_accvgpr_read_b32 v192, a120
    v_accvgpr_read_b32 v193, a121
    v_accvgpr_read_b32 v194, a122
    v_accvgpr_read_b32 v195, a123
    v_mul_f32 v192, v192, v216
    v_mul_f32 v193, v193, v216
    v_mul_f32 v194, v194, v216
    v_mul_f32 v195, v195, v216
    v_accvgpr_write_b32 a120, v192
    v_accvgpr_write_b32 a121, v193
    v_accvgpr_write_b32 a122, v194
    v_accvgpr_write_b32 a123, v195
    v_accvgpr_read_b32 v192, a124
    v_accvgpr_read_b32 v193, a125
    v_accvgpr_read_b32 v194, a126
    v_accvgpr_read_b32 v195, a127
    v_mul_f32 v192, v192, v216
    v_mul_f32 v193, v193, v216
    v_mul_f32 v194, v194, v216
    v_mul_f32 v195, v195, v216
    v_accvgpr_write_b32 a124, v192
    v_accvgpr_write_b32 a125, v193
    v_accvgpr_write_b32 a126, v194
    v_accvgpr_write_b32 a127, v195
    v_fma_f32 v184, v0, s28, v202
    v_fma_f32 v185, v1, s28, v202
    v_fma_f32 v186, v2, s28, v202
    v_fma_f32 v187, v3, s28, v202
    v_exp_f32 v184, v184
    v_exp_f32 v185, v185
    v_fma_f32 v188, v4, s28, v202
    v_fma_f32 v189, v5, s28, v202
    v_exp_f32 v186, v186
    v_exp_f32 v187, v187
    v_mov_b32 v203, v184
    v_mov_b32 v204, v185
    v_cvt_pk_bf16_f32 v64, v184, v185
    v_fma_f32 v190, v6, s28, v202
    v_fma_f32 v191, v7, s28, v202
    v_exp_f32 v188, v188
    v_exp_f32 v189, v189
    v_add_f32 v203, v203, v186
    v_add_f32 v204, v204, v187
    v_cvt_pk_bf16_f32 v65, v186, v187
    v_fma_f32 v184, v8, s28, v202
    v_fma_f32 v185, v9, s28, v202
    v_exp_f32 v190, v190
    v_exp_f32 v191, v191
    v_add_f32 v203, v203, v188
    v_add_f32 v204, v204, v189
    v_cvt_pk_bf16_f32 v66, v188, v189
    v_fma_f32 v186, v10, s28, v202
    v_fma_f32 v187, v11, s28, v202
    v_exp_f32 v184, v184
    v_exp_f32 v185, v185
    v_add_f32 v203, v203, v190
    v_add_f32 v204, v204, v191
    v_cvt_pk_bf16_f32 v67, v190, v191
    v_fma_f32 v188, v12, s28, v202
    v_fma_f32 v189, v13, s28, v202
    v_exp_f32 v186, v186
    v_exp_f32 v187, v187
    v_add_f32 v203, v203, v184
    v_add_f32 v204, v204, v185
    v_cvt_pk_bf16_f32 v68, v184, v185
    v_fma_f32 v190, v14, s28, v202
    v_fma_f32 v191, v15, s28, v202
    v_exp_f32 v188, v188
    v_exp_f32 v189, v189
    v_add_f32 v203, v203, v186
    v_add_f32 v204, v204, v187
    v_cvt_pk_bf16_f32 v69, v186, v187
    v_fma_f32 v184, v16, s28, v202
    v_fma_f32 v185, v17, s28, v202
    v_exp_f32 v190, v190
    v_exp_f32 v191, v191
    v_add_f32 v203, v203, v188
    v_add_f32 v204, v204, v189
    v_cvt_pk_bf16_f32 v70, v188, v189
    v_fma_f32 v186, v18, s28, v202
    v_fma_f32 v187, v19, s28, v202
    v_exp_f32 v184, v184
    v_exp_f32 v185, v185
    v_add_f32 v203, v203, v190
    v_add_f32 v204, v204, v191
    v_cvt_pk_bf16_f32 v71, v190, v191
    v_fma_f32 v188, v20, s28, v202
    v_fma_f32 v189, v21, s28, v202
    v_exp_f32 v186, v186
    v_exp_f32 v187, v187
    v_add_f32 v203, v203, v184
    v_add_f32 v204, v204, v185
    v_cvt_pk_bf16_f32 v72, v184, v185
    v_fma_f32 v190, v22, s28, v202
    v_fma_f32 v191, v23, s28, v202
    v_exp_f32 v188, v188
    v_exp_f32 v189, v189
    v_add_f32 v203, v203, v186
    v_add_f32 v204, v204, v187
    v_cvt_pk_bf16_f32 v73, v186, v187
    v_fma_f32 v184, v24, s28, v202
    v_fma_f32 v185, v25, s28, v202
    v_exp_f32 v190, v190
    v_exp_f32 v191, v191
    v_add_f32 v203, v203, v188
    v_add_f32 v204, v204, v189
    v_cvt_pk_bf16_f32 v74, v188, v189
    v_fma_f32 v186, v26, s28, v202
    v_fma_f32 v187, v27, s28, v202
    v_exp_f32 v184, v184
    v_exp_f32 v185, v185
    v_add_f32 v203, v203, v190
    v_add_f32 v204, v204, v191
    v_cvt_pk_bf16_f32 v75, v190, v191
    v_fma_f32 v188, v28, s28, v202
    v_fma_f32 v189, v29, s28, v202
    v_exp_f32 v186, v186
    v_exp_f32 v187, v187
    v_add_f32 v203, v203, v184
    v_add_f32 v204, v204, v185
    v_cvt_pk_bf16_f32 v76, v184, v185
    v_fma_f32 v190, v30, s28, v202
    v_fma_f32 v191, v31, s28, v202
    v_exp_f32 v188, v188
    v_exp_f32 v189, v189
    v_add_f32 v203, v203, v186
    v_add_f32 v204, v204, v187
    v_cvt_pk_bf16_f32 v77, v186, v187
    v_exp_f32 v190, v190
    v_exp_f32 v191, v191
    v_add_f32 v203, v203, v188
    v_add_f32 v204, v204, v189
    v_cvt_pk_bf16_f32 v78, v188, v189
    v_add_f32 v203, v203, v190
    v_add_f32 v204, v204, v191
    v_cvt_pk_bf16_f32 v79, v190, v191
    v_add_f32 v203, v203, v204
    s_add_u32 s40, s40, 4
    s_addc_u32 s41, s41, 0
    s_nop 1
    s_setpc_b64 s[40:41]
.Lrare1:
    v_max3_f32 v211, v32, v33, v34
    v_max3_f32 v212, v35, v36, v37
    v_max3_f32 v211, v211, v38, v39
    v_max3_f32 v212, v212, v40, v41
    v_max3_f32 v211, v211, v42, v43
    v_max3_f32 v212, v212, v44, v45
    v_max3_f32 v211, v211, v46, v47
    v_max3_f32 v212, v212, v48, v49
    v_max3_f32 v211, v211, v50, v51
    v_max3_f32 v212, v212, v52, v53
    v_max3_f32 v211, v211, v54, v55
    v_max3_f32 v212, v212, v56, v57
    v_max3_f32 v211, v211, v58, v59
    v_max3_f32 v212, v212, v60, v61
    v_max3_f32 v211, v211, v62, v63
    v_max_f32 v211, v211, v212
    v_mov_b32 v212, v211
    s_nop 1
    v_permlane32_swap_b32 v211, v212
    v_max_f32 v211, v211, v212
    v_max_f32 v211, v211, v201
    v_sub_f32 v212, v201, v211
    v_mul_f32 v212, s28, v212
    v_exp_f32 v216, v212
    v_mov_b32 v201, v211
    v_mul_f32 v202, s28, v201
    v_sub_f32 v202, 0, v202
    v_mul_f32 v200, v200, v216
    v_accvgpr_read_b32 v192, a0
    v_accvgpr_read_b32 v193, a1
    v_accvgpr_read_b32 v194, a2
    v_accvgpr_read_b32 v195, a3
    v_mul_f32 v192, v192, v216
    v_mul_f32 v193, v193, v216
    v_mul_f32 v194, v194, v216
    v_mul_f32 v195, v195, v216
    v_accvgpr_write_b32 a0, v192
    v_accvgpr_write_b32 a1, v193
    v_accvgpr_write_b32 a2, v194
    v_accvgpr_write_b32 a3, v195
    v_accvgpr_read_b32 v192, a4
    v_accvgpr_read_b32 v193, a5
    v_accvgpr_read_b32 v194, a6
    v_accvgpr_read_b32 v195, a7
    v_mul_f32 v192, v192, v216
    v_mul_f32 v193, v193, v216
    v_mul_f32 v194, v194, v216
    v_mul_f32 v195, v195, v216
    v_accvgpr_write_b32 a4, v192
    v_accvgpr_write_b32 a5, v193
    v_accvgpr_write_b32 a6, v194
    v_accvgpr_write_b32 a7, v195
    v_accvgpr_read_b32 v192, a8
    v_accvgpr_read_b32 v193, a9
    v_accvgpr_read_b32 v194, a10
    v_accvgpr_read_b32 v195, a11
    v_mul_f32 v192, v192, v216
    v_mul_f32 v193, v193, v216
    v_mul_f32 v194, v194, v216
    v_mul_f32 v195, v195, v216
    v_accvgpr_write_b32 a8, v192
    v_accvgpr_write_b32 a9, v193
    v_accvgpr_write_b32 a10, v194
    v_accvgpr_write_b32 a11, v195
    v_accvgpr_read_b32 v192, a12
    v_accvgpr_read_b32 v193, a13
    v_accvgpr_read_b32 v194, a14
    v_accvgpr_read_b32 v195, a15
    v_mul_f32 v192, v192, v216
    v_mul_f32 v193, v193, v216
    v_mul_f32 v194, v194, v216
    v_mul_f32 v195, v195, v216
    v_accvgpr_write_b32 a12, v192
    v_accvgpr_write_b32 a13, v193
    v_accvgpr_write_b32 a14, v194
    v_accvgpr_write_b32 a15, v195
    v_accvgpr_read_b32 v192, a16
    v_accvgpr_read_b32 v193, a17
    v_accvgpr_read_b32 v194, a18
    v_accvgpr_read_b32 v195, a19
    v_mul_f32 v192, v192, v216
    v_mul_f32 v193, v193, v216
    v_mul_f32 v194, v194, v216
    v_mul_f32 v195, v195, v216
    v_accvgpr_write_b32 a16, v192
    v_accvgpr_write_b32 a17, v193
    v_accvgpr_write_b32 a18, v194
    v_accvgpr_write_b32 a19, v195
    v_accvgpr_read_b32 v192, a20
    v_accvgpr_read_b32 v193, a21
    v_accvgpr_read_b32 v194, a22
    v_accvgpr_read_b32 v195, a23
    v_mul_f32 v192, v192, v216
    v_mul_f32 v193, v193, v216
    v_mul_f32 v194, v194, v216
    v_mul_f32 v195, v195, v216
    v_accvgpr_write_b32 a20, v192
    v_accvgpr_write_b32 a21, v193
    v_accvgpr_write_b32 a22, v194
    v_accvgpr_write_b32 a23, v195
    v_accvgpr_read_b32 v192, a24
    v_accvgpr_read_b32 v193, a25
    v_accvgpr_read_b32 v194, a26
    v_accvgpr_read_b32 v195, a27
    v_mul_f32 v192, v192, v216
    v_mul_f32 v193, v193, v216
    v_mul_f32 v194, v194, v216
    v_mul_f32 v195, v195, v216
    v_accvgpr_write_b32 a24, v192
    v_accvgpr_write_b32 a25, v193
    v_accvgpr_write_b32 a26, v194
    v_accvgpr_write_b32 a27, v195
    v_accvgpr_read_b32 v192, a28
    v_accvgpr_read_b32 v193, a29
    v_accvgpr_read_b32 v194, a30
    v_accvgpr_read_b32 v195, a31
    v_mul_f32 v192, v192, v216
    v_mul_f32 v193, v193, v216
    v_mul_f32 v194, v194, v216
    v_mul_f32 v195, v195, v216
    v_accvgpr_write_b32 a28, v192
    v_accvgpr_write_b32 a29, v193
    v_accvgpr_write_b32 a30, v194
    v_accvgpr_write_b32 a31, v195
    v_accvgpr_read_b32 v192, a32
    v_accvgpr_read_b32 v193, a33
    v_accvgpr_read_b32 v194, a34
    v_accvgpr_read_b32 v195, a35
    v_mul_f32 v192, v192, v216
    v_mul_f32 v193, v193, v216
    v_mul_f32 v194, v194, v216
    v_mul_f32 v195, v195, v216
    v_accvgpr_write_b32 a32, v192
    v_accvgpr_write_b32 a33, v193
    v_accvgpr_write_b32 a34, v194
    v_accvgpr_write_b32 a35, v195
    v_accvgpr_read_b32 v192, a36
    v_accvgpr_read_b32 v193, a37
    v_accvgpr_read_b32 v194, a38
    v_accvgpr_read_b32 v195, a39
    v_mul_f32 v192, v192, v216
    v_mul_f32 v193, v193, v216
    v_mul_f32 v194, v194, v216
    v_mul_f32 v195, v195, v216
    v_accvgpr_write_b32 a36, v192
    v_accvgpr_write_b32 a37, v193
    v_accvgpr_write_b32 a38, v194
    v_accvgpr_write_b32 a39, v195
    v_accvgpr_read_b32 v192, a40
    v_accvgpr_read_b32 v193, a41
    v_accvgpr_read_b32 v194, a42
    v_accvgpr_read_b32 v195, a43
    v_mul_f32 v192, v192, v216
    v_mul_f32 v193, v193, v216
    v_mul_f32 v194, v194, v216
    v_mul_f32 v195, v195, v216
    v_accvgpr_write_b32 a40, v192
    v_accvgpr_write_b32 a41, v193
    v_accvgpr_write_b32 a42, v194
    v_accvgpr_write_b32 a43, v195
    v_accvgpr_read_b32 v192, a44
    v_accvgpr_read_b32 v193, a45
    v_accvgpr_read_b32 v194, a46
    v_accvgpr_read_b32 v195, a47
    v_mul_f32 v192, v192, v216
    v_mul_f32 v193, v193, v216
    v_mul_f32 v194, v194, v216
    v_mul_f32 v195, v195, v216
    v_accvgpr_write_b32 a44, v192
    v_accvgpr_write_b32 a45, v193
    v_accvgpr_write_b32 a46, v194
    v_accvgpr_write_b32 a47, v195
    v_accvgpr_read_b32 v192, a48
    v_accvgpr_read_b32 v193, a49
    v_accvgpr_read_b32 v194, a50
    v_accvgpr_read_b32 v195, a51
    v_mul_f32 v192, v192, v216
    v_mul_f32 v193, v193, v216
    v_mul_f32 v194, v194, v216
    v_mul_f32 v195, v195, v216
    v_accvgpr_write_b32 a48, v192
    v_accvgpr_write_b32 a49, v193
    v_accvgpr_write_b32 a50, v194
    v_accvgpr_write_b32 a51, v195
    v_accvgpr_read_b32 v192, a52
    v_accvgpr_read_b32 v193, a53
    v_accvgpr_read_b32 v194, a54
    v_accvgpr_read_b32 v195, a55
    v_mul_f32 v192, v192, v216
    v_mul_f32 v193, v193, v216
    v_mul_f32 v194, v194, v216
    v_mul_f32 v195, v195, v216
    v_accvgpr_write_b32 a52, v192
    v_accvgpr_write_b32 a53, v193
    v_accvgpr_write_b32 a54, v194
    v_accvgpr_write_b32 a55, v195
    v_accvgpr_read_b32 v192, a56
    v_accvgpr_read_b32 v193, a57
    v_accvgpr_read_b32 v194, a58
    v_accvgpr_read_b32 v195, a59
    v_mul_f32 v192, v192, v216
    v_mul_f32 v193, v193, v216
    v_mul_f32 v194, v194, v216
    v_mul_f32 v195, v195, v216
    v_accvgpr_write_b32 a56, v192
    v_accvgpr_write_b32 a57, v193
    v_accvgpr_write_b32 a58, v194
    v_accvgpr_write_b32 a59, v195
    v_accvgpr_read_b32 v192, a60
    v_accvgpr_read_b32 v193, a61
    v_accvgpr_read_b32 v194, a62
    v_accvgpr_read_b32 v195, a63
    v_mul_f32 v192, v192, v216
    v_mul_f32 v193, v193, v216
    v_mul_f32 v194, v194, v216
    v_mul_f32 v195, v195, v216
    v_accvgpr_write_b32 a60, v192
    v_accvgpr_write_b32 a61, v193
    v_accvgpr_write_b32 a62, v194
    v_accvgpr_write_b32 a63, v195
    v_accvgpr_read_b32 v192, a64
    v_accvgpr_read_b32 v193, a65
    v_accvgpr_read_b32 v194, a66
    v_accvgpr_read_b32 v195, a67
    v_mul_f32 v192, v192, v216
    v_mul_f32 v193, v193, v216
    v_mul_f32 v194, v194, v216
    v_mul_f32 v195, v195, v216
    v_accvgpr_write_b32 a64, v192
    v_accvgpr_write_b32 a65, v193
    v_accvgpr_write_b32 a66, v194
    v_accvgpr_write_b32 a67, v195
    v_accvgpr_read_b32 v192, a68
    v_accvgpr_read_b32 v193, a69
    v_accvgpr_read_b32 v194, a70
    v_accvgpr_read_b32 v195, a71
    v_mul_f32 v192, v192, v216
    v_mul_f32 v193, v193, v216
    v_mul_f32 v194, v194, v216
    v_mul_f32 v195, v195, v216
    v_accvgpr_write_b32 a68, v192
    v_accvgpr_write_b32 a69, v193
    v_accvgpr_write_b32 a70, v194
    v_accvgpr_write_b32 a71, v195
    v_accvgpr_read_b32 v192, a72
    v_accvgpr_read_b32 v193, a73
    v_accvgpr_read_b32 v194, a74
    v_accvgpr_read_b32 v195, a75
    v_mul_f32 v192, v192, v216
    v_mul_f32 v193, v193, v216
    v_mul_f32 v194, v194, v216
    v_mul_f32 v195, v195, v216
    v_accvgpr_write_b32 a72, v192
    v_accvgpr_write_b32 a73, v193
    v_accvgpr_write_b32 a74, v194
    v_accvgpr_write_b32 a75, v195
    v_accvgpr_read_b32 v192, a76
    v_accvgpr_read_b32 v193, a77
    v_accvgpr_read_b32 v194, a78
    v_accvgpr_read_b32 v195, a79
    v_mul_f32 v192, v192, v216
    v_mul_f32 v193, v193, v216
    v_mul_f32 v194, v194, v216
    v_mul_f32 v195, v195, v216
    v_accvgpr_write_b32 a76, v192
    v_accvgpr_write_b32 a77, v193
    v_accvgpr_write_b32 a78, v194
    v_accvgpr_write_b32 a79, v195
    v_accvgpr_read_b32 v192, a80
    v_accvgpr_read_b32 v193, a81
    v_accvgpr_read_b32 v194, a82
    v_accvgpr_read_b32 v195, a83
    v_mul_f32 v192, v192, v216
    v_mul_f32 v193, v193, v216
    v_mul_f32 v194, v194, v216
    v_mul_f32 v195, v195, v216
    v_accvgpr_write_b32 a80, v192
    v_accvgpr_write_b32 a81, v193
    v_accvgpr_write_b32 a82, v194
    v_accvgpr_write_b32 a83, v195
    v_accvgpr_read_b32 v192, a84
    v_accvgpr_read_b32 v193, a85
    v_accvgpr_read_b32 v194, a86
    v_accvgpr_read_b32 v195, a87
    v_mul_f32 v192, v192, v216
    v_mul_f32 v193, v193, v216
    v_mul_f32 v194, v194, v216
    v_mul_f32 v195, v195, v216
    v_accvgpr_write_b32 a84, v192
    v_accvgpr_write_b32 a85, v193
    v_accvgpr_write_b32 a86, v194
    v_accvgpr_write_b32 a87, v195
    v_accvgpr_read_b32 v192, a88
    v_accvgpr_read_b32 v193, a89
    v_accvgpr_read_b32 v194, a90
    v_accvgpr_read_b32 v195, a91
    v_mul_f32 v192, v192, v216
    v_mul_f32 v193, v193, v216
    v_mul_f32 v194, v194, v216
    v_mul_f32 v195, v195, v216
    v_accvgpr_write_b32 a88, v192
    v_accvgpr_write_b32 a89, v193
    v_accvgpr_write_b32 a90, v194
    v_accvgpr_write_b32 a91, v195
    v_accvgpr_read_b32 v192, a92
    v_accvgpr_read_b32 v193, a93
    v_accvgpr_read_b32 v194, a94
    v_accvgpr_read_b32 v195, a95
    v_mul_f32 v192, v192, v216
    v_mul_f32 v193, v193, v216
    v_mul_f32 v194, v194, v216
    v_mul_f32 v195, v195, v216
    v_accvgpr_write_b32 a92, v192
    v_accvgpr_write_b32 a93, v193
    v_accvgpr_write_b32 a94, v194
    v_accvgpr_write_b32 a95, v195
    v_accvgpr_read_b32 v192, a96
    v_accvgpr_read_b32 v193, a97
    v_accvgpr_read_b32 v194, a98
    v_accvgpr_read_b32 v195, a99
    v_mul_f32 v192, v192, v216
    v_mul_f32 v193, v193, v216
    v_mul_f32 v194, v194, v216
    v_mul_f32 v195, v195, v216
    v_accvgpr_write_b32 a96, v192
    v_accvgpr_write_b32 a97, v193
    v_accvgpr_write_b32 a98, v194
    v_accvgpr_write_b32 a99, v195
    v_accvgpr_read_b32 v192, a100
    v_accvgpr_read_b32 v193, a101
    v_accvgpr_read_b32 v194, a102
    v_accvgpr_read_b32 v195, a103
    v_mul_f32 v192, v192, v216
    v_mul_f32 v193, v193, v216
    v_mul_f32 v194, v194, v216
    v_mul_f32 v195, v195, v216
    v_accvgpr_write_b32 a100, v192
    v_accvgpr_write_b32 a101, v193
    v_accvgpr_write_b32 a102, v194
    v_accvgpr_write_b32 a103, v195
    v_accvgpr_read_b32 v192, a104
    v_accvgpr_read_b32 v193, a105
    v_accvgpr_read_b32 v194, a106
    v_accvgpr_read_b32 v195, a107
    v_mul_f32 v192, v192, v216
    v_mul_f32 v193, v193, v216
    v_mul_f32 v194, v194, v216
    v_mul_f32 v195, v195, v216
    v_accvgpr_write_b32 a104, v192
    v_accvgpr_write_b32 a105, v193
    v_accvgpr_write_b32 a106, v194
    v_accvgpr_write_b32 a107, v195
    v_accvgpr_read_b32 v192, a108
    v_accvgpr_read_b32 v193, a109
    v_accvgpr_read_b32 v194, a110
    v_accvgpr_read_b32 v195, a111
    v_mul_f32 v192, v192, v216
    v_mul_f32 v193, v193, v216
    v_mul_f32 v194, v194, v216
    v_mul_f32 v195, v195, v216
    v_accvgpr_write_b32 a108, v192
    v_accvgpr_write_b32 a109, v193
    v_accvgpr_write_b32 a110, v194
    v_accvgpr_write_b32 a111, v195
    v_accvgpr_read_b32 v192, a112
    v_accvgpr_read_b32 v193, a113
    v_accvgpr_read_b32 v194, a114
    v_accvgpr_read_b32 v195, a115
    v_mul_f32 v192, v192, v216
    v_mul_f32 v193, v193, v216
    v_mul_f32 v194, v194, v216
    v_mul_f32 v195, v195, v216
    v_accvgpr_write_b32 a112, v192
    v_accvgpr_write_b32 a113, v193
    v_accvgpr_write_b32 a114, v194
    v_accvgpr_write_b32 a115, v195
    v_accvgpr_read_b32 v192, a116
    v_accvgpr_read_b32 v193, a117
    v_accvgpr_read_b32 v194, a118
    v_accvgpr_read_b32 v195, a119
    v_mul_f32 v192, v192, v216
    v_mul_f32 v193, v193, v216
    v_mul_f32 v194, v194, v216
    v_mul_f32 v195, v195, v216
    v_accvgpr_write_b32 a116, v192
    v_accvgpr_write_b32 a117, v193
    v_accvgpr_write_b32 a118, v194
    v_accvgpr_write_b32 a119, v195
    v_accvgpr_read_b32 v192, a120
    v_accvgpr_read_b32 v193, a121
    v_accvgpr_read_b32 v194, a122
    v_accvgpr_read_b32 v195, a123
    v_mul_f32 v192, v192, v216
    v_mul_f32 v193, v193, v216
    v_mul_f32 v194, v194, v216
    v_mul_f32 v195, v195, v216
    v_accvgpr_write_b32 a120, v192
    v_accvgpr_write_b32 a121, v193
    v_accvgpr_write_b32 a122, v194
    v_accvgpr_write_b32 a123, v195
    v_accvgpr_read_b32 v192, a124
    v_accvgpr_read_b32 v193, a125
    v_accvgpr_read_b32 v194, a126
    v_accvgpr_read_b32 v195, a127
    v_mul_f32 v192, v192, v216
    v_mul_f32 v193, v193, v216
    v_mul_f32 v194, v194, v216
    v_mul_f32 v195, v195, v216
    v_accvgpr_write_b32 a124, v192
    v_accvgpr_write_b32 a125, v193
    v_accvgpr_write_b32 a126, v194
    v_accvgpr_write_b32 a127, v195
    v_fma_f32 v184, v32, s28, v202
    v_fma_f32 v185, v33, s28, v202
    v_fma_f32 v186, v34, s28, v202
    v_fma_f32 v187, v35, s28, v202
    v_exp_f32 v184, v184
    v_exp_f32 v185, v185
    v_fma_f32 v188, v36, s28, v202
    v_fma_f32 v189, v37, s28, v202
    v_exp_f32 v186, v186
    v_exp_f32 v187, v187
    v_mov_b32 v203, v184
    v_mov_b32 v204, v185
    v_cvt_pk_bf16_f32 v80, v184, v185
    v_fma_f32 v190, v38, s28, v202
    v_fma_f32 v191, v39, s28, v202
    v_exp_f32 v188, v188
    v_exp_f32 v189, v189
    v_add_f32 v203, v203, v186
    v_add_f32 v204, v204, v187
    v_cvt_pk_bf16_f32 v81, v186, v187
    v_fma_f32 v184, v40, s28, v202
    v_fma_f32 v185, v41, s28, v202
    v_exp_f32 v190, v190
    v_exp_f32 v191, v191
    v_add_f32 v203, v203, v188
    v_add_f32 v204, v204, v189
    v_cvt_pk_bf16_f32 v82, v188, v189
    v_fma_f32 v186, v42, s28, v202
    v_fma_f32 v187, v43, s28, v202
    v_exp_f32 v184, v184
    v_exp_f32 v185, v185
    v_add_f32 v203, v203, v190
    v_add_f32 v204, v204, v191
    v_cvt_pk_bf16_f32 v83, v190, v191
    v_fma_f32 v188, v44, s28, v202
    v_fma_f32 v189, v45, s28, v202
    v_exp_f32 v186, v186
    v_exp_f32 v187, v187
    v_add_f32 v203, v203, v184
    v_add_f32 v204, v204, v185
    v_cvt_pk_bf16_f32 v84, v184, v185
    v_fma_f32 v190, v46, s28, v202
    v_fma_f32 v191, v47, s28, v202
    v_exp_f32 v188, v188
    v_exp_f32 v189, v189
    v_add_f32 v203, v203, v186
    v_add_f32 v204, v204, v187
    v_cvt_pk_bf16_f32 v85, v186, v187
    v_fma_f32 v184, v48, s28, v202
    v_fma_f32 v185, v49, s28, v202
    v_exp_f32 v190, v190
    v_exp_f32 v191, v191
    v_add_f32 v203, v203, v188
    v_add_f32 v204, v204, v189
    v_cvt_pk_bf16_f32 v86, v188, v189
    v_fma_f32 v186, v50, s28, v202
    v_fma_f32 v187, v51, s28, v202
    v_exp_f32 v184, v184
    v_exp_f32 v185, v185
    v_add_f32 v203, v203, v190
    v_add_f32 v204, v204, v191
    v_cvt_pk_bf16_f32 v87, v190, v191
    v_fma_f32 v188, v52, s28, v202
    v_fma_f32 v189, v53, s28, v202
    v_exp_f32 v186, v186
    v_exp_f32 v187, v187
    v_add_f32 v203, v203, v184
    v_add_f32 v204, v204, v185
    v_cvt_pk_bf16_f32 v88, v184, v185
    v_fma_f32 v190, v54, s28, v202
    v_fma_f32 v191, v55, s28, v202
    v_exp_f32 v188, v188
    v_exp_f32 v189, v189
    v_add_f32 v203, v203, v186
    v_add_f32 v204, v204, v187
    v_cvt_pk_bf16_f32 v89, v186, v187
    v_fma_f32 v184, v56, s28, v202
    v_fma_f32 v185, v57, s28, v202
    v_exp_f32 v190, v190
    v_exp_f32 v191, v191
    v_add_f32 v203, v203, v188
    v_add_f32 v204, v204, v189
    v_cvt_pk_bf16_f32 v90, v188, v189
    v_fma_f32 v186, v58, s28, v202
    v_fma_f32 v187, v59, s28, v202
    v_exp_f32 v184, v184
    v_exp_f32 v185, v185
    v_add_f32 v203, v203, v190
    v_add_f32 v204, v204, v191
    v_cvt_pk_bf16_f32 v91, v190, v191
    v_fma_f32 v188, v60, s28, v202
    v_fma_f32 v189, v61, s28, v202
    v_exp_f32 v186, v186
    v_exp_f32 v187, v187
    v_add_f32 v203, v203, v184
    v_add_f32 v204, v204, v185
    v_cvt_pk_bf16_f32 v92, v184, v185
    v_fma_f32 v190, v62, s28, v202
    v_fma_f32 v191, v63, s28, v202
    v_exp_f32 v188, v188
    v_exp_f32 v189, v189
    v_add_f32 v203, v203, v186
    v_add_f32 v204, v204, v187
    v_cvt_pk_bf16_f32 v93, v186, v187
    v_exp_f32 v190, v190
    v_exp_f32 v191, v191
    v_add_f32 v203, v203, v188
    v_add_f32 v204, v204, v189
    v_cvt_pk_bf16_f32 v94, v188, v189
    v_add_f32 v203, v203, v190
    v_add_f32 v204, v204, v191
    v_cvt_pk_bf16_f32 v95, v190, v191
    v_add_f32 v203, v203, v204
    s_add_u32 s40, s40, 4
    s_addc_u32 s41, s41, 0
    s_nop 1
    s_setpc_b64 s[40:41]
.Lfin:
.Lend:
    s_endpgm
.section .rodata,"a"
.p2align 6
.amdhsa_kernel standalone__softmax_full_causal__prompt_kernel
  .amdhsa_next_free_vgpr 512
  .amdhsa_next_free_sgpr 102
  .amdhsa_accum_offset 256
  .amdhsa_group_segment_fixed_size 0
  .amdhsa_kernarg_size 48
  .amdhsa_user_sgpr_count 2
  .amdhsa_user_sgpr_kernarg_segment_ptr 1
  .amdhsa_system_sgpr_workgroup_id_x 1
.end_amdhsa_kernel
```
